```python
import torch

def _softmax(x, axis=-1):
    return torch.softmax(x, dim=axis)
def _gelu(x):
    return torch.nn.functional.gelu(x, approximate="tanh")
def _silu(x):
    return torch.nn.functional.silu(x)
def _sigmoid(x):
    return torch.sigmoid(x)
def _layernorm(x, axis=-1, eps=1e-5):
    m = x.mean(dim=axis, keepdim=True)
    v = x.var(dim=axis, keepdim=True, unbiased=False)
    return (x - m) / torch.sqrt(v + eps)
def _scatter_add(tgt, idx, src, axis=0):
    return tgt.clone().index_add_(axis, idx, src)
def _segment_sum(src, seg, n):
    out = torch.zeros((n,) + src.shape[1:], dtype=src.dtype)
    return out.index_add_(0, seg, src)
def _pad(x, pw):
    flat = tuple(v for pair in reversed(pw) for v in pair)
    return torch.nn.functional.pad(x, flat)

kernel_name = 'interleave_layers__spectral_gfnet__spectral_gfnet__prompt'

def setup_inputs():

    _w = (lambda a: (lambda t: t.to(torch.bfloat16) if t.is_floating_point() else t)(torch.as_tensor(a)))
    def _A_setup():
        B, S, D = 1, 2048, 1024
        Df = D // 2 + 1
        return {
            "x": _w((lambda *s: torch.randn(*s, dtype=torch.bfloat16) * 0.05)(B, S, D)),
            "w_r": _w((lambda *s: torch.randn(*s, dtype=torch.bfloat16) * 0.2)(S, Df) * 0.02),
            "w_i": _w((lambda *s: torch.randn(*s, dtype=torch.bfloat16) * 0.2)(S, Df) * 0.02),
        }
    _A_in = _A_setup()

    def _B_setup():
        B, S, D = 1, 2048, 1024
        Df = D // 2 + 1
        return {
            "x": _w((lambda *s: torch.randn(*s, dtype=torch.bfloat16) * 0.05)(B, S, D)),
            "w_r": _w((lambda *s: torch.randn(*s, dtype=torch.bfloat16) * 0.2)(S, Df) * 0.02),
            "w_i": _w((lambda *s: torch.randn(*s, dtype=torch.bfloat16) * 0.2)(S, Df) * 0.02),
        }
    _B_in = _B_setup()

    return {
        "A_x": _A_in["x"],
        "A_w_r": _A_in["w_r"],
        "A_w_i": _A_in["w_i"],
        "B_x": _B_in["x"],
        "B_w_r": _B_in["w_r"],
        "B_w_i": _B_in["w_i"],
    }

def reference(A_x, A_w_r, A_w_i, B_x, B_w_r, B_w_i):
    def _A_ref(x, w_r, w_i):
        B, S, D = x.shape
        X = (lambda x, axes=(-2,-1): torch.fft.rfft2(x.float(), dim=axes))(x, axes=(-2, -1))
        W = w_r + 1j * w_i
        X = X * W
        y = (lambda x, s, axes=(-2,-1): torch.fft.irfft2(x, s=s, dim=axes).to(torch.bfloat16))(X, (S, D), axes=(-2, -1))
        return y

    def _B_ref(x, w_r, w_i):
        B, S, D = x.shape
        X = (lambda x, axes=(-2,-1): torch.fft.rfft2(x.float(), dim=axes))(x, axes=(-2, -1))
        W = w_r + 1j * w_i
        X = X * W
        y = (lambda x, s, axes=(-2,-1): torch.fft.irfft2(x, s=s, dim=axes).to(torch.bfloat16))(X, (S, D), axes=(-2, -1))
        return y

    x = A_x
    x = x + _A_ref(_layernorm(x, axis=-1), A_w_r, A_w_i)
    x = x + _B_ref(_layernorm(x, axis=-1), B_w_r, B_w_i)
    x = x + _A_ref(_layernorm(x, axis=-1), A_w_r, A_w_i)
    x = x + _B_ref(_layernorm(x, axis=-1), B_w_r, B_w_i)
    return x
```

```asm
; @launch grid=(256,1,1) block=(512,1,1) lds=162304
.amdgcn_target "amdgcn-amd-amdhsa--gfx950"
.text
.globl interleave_layers__spectral_gfnet__spectral_gfnet__prompt_kernel
.p2align 8
.type interleave_layers__spectral_gfnet__spectral_gfnet__prompt_kernel,@function
interleave_layers__spectral_gfnet__spectral_gfnet__prompt_kernel:
    s_cmp_ge_u32 s2, 256
    s_cbranch_scc1 L_END
    s_load_dwordx16 s[28:43], s[0:1], 0
    s_load_dwordx2 s[8:9], s[0:1], 64
    v_readfirstlane_b32 s3, v0
    s_bfe_u32 s16, s2, 0x30004
    s_lshl_b32 s16, s16, 19
    s_and_b32 s17, s2, 15
    s_lshl_b32 s17, s17, 13
    s_add_u32 s16, s16, s17
    s_lshr_b32 s17, s2, 7
    s_add_u32 s17, s17, 1
    s_lshl_b32 s17, s17, 11
    s_add_u32 s16, s16, s17
    s_lshl_b32 s17, s3, 11
    s_add_u32 s17, s17, s16
    v_and_b32 v242, 31, v0
    v_and_b32 v5, 32, v0
    v_lshl_add_u32 v4, v242, 6, v5
    v_add_u32 v5, s17, v4
    s_cmp_ge_u32 s3, 256
    s_nop 0
    s_cbranch_scc1 L_NOX
    s_waitcnt lgkmcnt(0)
    global_load_dwordx4 v[8:11], v5, s[28:29] offset:-2048
    global_load_dwordx4 v[12:15], v5, s[28:29] offset:-2032
    global_load_dwordx4 v[16:19], v5, s[28:29] offset:2048
    global_load_dwordx4 v[20:23], v5, s[28:29] offset:2064
    s_getpc_b64 s[6:7]
L_PC:
    s_lshr_b32 s17, s2, 3
    s_lshl_b32 s17, s17, 10
    s_lshl_b32 s18, s3, 2
    s_add_u32 s17, s17, s18
    v_and_b32 v1, 1, v0
    v_lshl_add_u32 v1, v1, 7, s17
    v_min_u32 v1, L_END-L_PC, v1
    global_load_dword v234, v1, s[6:7]
    v_mov_b32 v232, 0
    v_mov_b32 v233, 0
    s_barrier
    s_nop 0
    s_branch L_COMMON
L_NOX:
    s_and_b32 s17, s2, 31
    s_lshr_b32 s18, s2, 5
    s_lshl_b32 s18, s18, 7
    s_add_u32 s17, s17, s18
    s_mul_i32 s17, s17, 1026
    s_and_b32 s17, s17, 0xfffffffc
    s_mul_i32 s18, s3, 513
    s_add_u32 s17, s17, s18
    s_sub_u32 s17, s17, 131328
    v_and_b32 v5, 63, v0
    v_lshl_add_u32 v232, v5, 3, s17
    v_add_u32 v233, 1050624, v232
    v_mov_b32 v236, 0
    v_mov_b32 v237, 0
    v_mov_b32 v238, 0
    v_mov_b32 v239, 0
    v_lshlrev_b32 v6, 1, v5
    v_and_b32 v6, 0x78, v6
    ds_write_b64 v6, v[236:237] offset:24576
    s_waitcnt lgkmcnt(0)
    s_barrier
    s_nop 0
    global_load_dwordx3 v[160:162], v232, s[30:31] offset:0 nt
    global_load_dwordx3 v[164:166], v233, s[30:31] offset:0 nt
    global_load_dwordx3 v[168:170], v232, s[32:33] offset:0 nt
    global_load_dwordx3 v[172:174], v233, s[32:33] offset:0 nt
    global_load_dwordx3 v[176:178], v232, s[30:31] offset:512 nt
    global_load_dwordx3 v[180:182], v233, s[30:31] offset:512 nt
    global_load_dwordx3 v[184:186], v232, s[32:33] offset:512 nt
    global_load_dwordx3 v[188:190], v233, s[32:33] offset:512 nt
    global_load_dwordx3 v[192:194], v232, s[36:37] offset:0 nt
    global_load_dwordx3 v[196:198], v233, s[36:37] offset:0 nt
    global_load_dwordx3 v[200:202], v232, s[38:39] offset:0 nt
    global_load_dwordx3 v[204:206], v233, s[38:39] offset:0 nt
    global_load_dwordx3 v[208:210], v232, s[36:37] offset:512 nt
    global_load_dwordx3 v[212:214], v233, s[36:37] offset:512 nt
    global_load_dwordx3 v[216:218], v232, s[38:39] offset:512 nt
    global_load_dwordx3 v[220:222], v233, s[38:39] offset:512 nt
    s_mov_b32 s15, s17
L_COMMON:
    s_add_u32 s4, s8, 0x1350000
    s_addc_u32 s5, s9, 0
    s_load_dword s34, s[4:5], 0
    s_lshr_b32 s3, s3, 6
    v_mov_b32 v240, v0
    v_and_b32 v241, 63, v0
    v_bfe_u32 v243, v0, 5, 1
    v_lshlrev_b32 v244, 4, v241
    s_and_b32 s12, s3, 3
    s_lshr_b32 s13, s3, 2
    s_lshl_b32 s17, s12, 17
    s_lshl_b32 s18, s13, 12
    s_add_u32 s26, s16, s17
    s_add_u32 s26, s26, s18
    s_sub_u32 s26, s26, 2048
    s_mov_b32 s10, 0x10000000
    s_mov_b32 s11, 0x00020000
    v_mov_b32 v236, 0
    v_mov_b32 v237, 0
    v_mov_b32 v238, 0
    v_mov_b32 v239, 0
    v_lshlrev_b32 v5, 3, v241
    v_and_b32 v246, 1, v0
    v_mul_u32_u24 v246, 8256, v246
    v_lshrrev_b32 v92, 1, v0
    v_lshl_add_u32 v246, v92, 2, v246
    v_add_u32 v246, 63744, v246
    s_lshl_b32 s19, s3, 11
    s_lshl_b32 s24, s13, 6
    s_add_u32 s19, s19, s24
    s_add_u32 s19, s19, 63744
    v_add_u32 v250, s19, v244
    s_mov_b32 s20, s28
    s_mov_b32 s21, s29
    s_mov_b32 s22, 0x400000
    s_mov_b32 s23, 0x00020000
    s_lshl_b32 s19, s2, 6
    v_mov_b32 v255, 0
    v_mov_b32 v254, 1
    s_cmp_ge_u32 s3, 4
    s_nop 0
    s_cbranch_scc1 L_HELPER
    s_lshl_b32 s24, s3, 3
    v_lshl_add_u32 v92, v243, 2, s24
    v_cvt_f32_u32 v92, v92
    v_cvt_f32_u32 v94, v242
    v_cmp_eq_u32 vcc, 0, v242
    v_mov_b32 v95, 0x42000000
    v_mul_f32 v96, 0x3d000000, v94
    v_cndmask_b32 v95, v94, v95, vcc
    v_mov_b32 v235, 0x3d000000
    v_cndmask_b32_e64 v235, 0, v235, vcc
    v_mul_f32 v95, 0x3a800000, v95
    v_mul_f32 v97, 0x3a800000, v94
    v_mul_f32 v98, 0x3a000000, v94
    s_lshl_b32 s24, s3, 10
    v_add_u32 v6, s24, v244
    s_lshr_b32 s24, s3, 1
    s_lshl_b32 s24, s24, 10
    s_and_b32 s25, s3, 1
    s_lshl_b32 s25, s25, 3
    s_add_u32 s24, s24, s25
    v_add_u32 v7, s24, v244
    s_mov_b32 s24, 0x3d000000
    v_mul_f32 v100, v92, v96
    v_mul_f32 v104, v92, v95
    v_mul_f32 v108, v92, v97
    v_fmamk_f32 v112, v92, 0x3c800000, v98
    v_fract_f32 v100, v100
    v_add_f32 v92, 1.0, v92
    v_mul_f32 v101, v92, v96
    v_mul_f32 v105, v92, v95
    v_mul_f32 v109, v92, v97
    v_fmamk_f32 v113, v92, 0x3c800000, v98
    v_fract_f32 v101, v101
    v_add_f32 v92, 1.0, v92
    v_mul_f32 v102, v92, v96
    v_mul_f32 v106, v92, v95
    v_mul_f32 v110, v92, v97
    v_fmamk_f32 v114, v92, 0x3c800000, v98
    v_fract_f32 v102, v102
    v_add_f32 v92, 1.0, v92
    v_mul_f32 v103, v92, v96
    v_mul_f32 v107, v92, v95
    v_mul_f32 v111, v92, v97
    v_fmamk_f32 v115, v92, 0x3c800000, v98
    v_fract_f32 v103, v103
    v_cos_f32 v116, v100
    v_sin_f32 v132, v100
    v_cos_f32 v117, v101
    v_sin_f32 v133, v101
    v_cos_f32 v118, v102
    v_sin_f32 v134, v102
    v_cos_f32 v119, v103
    v_sin_f32 v135, v103
    v_cos_f32 v120, v104
    v_sin_f32 v136, v104
    v_cos_f32 v121, v105
    v_sin_f32 v137, v105
    v_cos_f32 v122, v106
    v_sin_f32 v138, v106
    v_cos_f32 v123, v107
    v_sin_f32 v139, v107
    v_cos_f32 v124, v108
    v_sin_f32 v140, v108
    v_cos_f32 v125, v109
    v_sin_f32 v141, v109
    v_cos_f32 v126, v110
    v_sin_f32 v142, v110
    v_cos_f32 v127, v111
    v_sin_f32 v143, v111
    v_cos_f32 v128, v112
    v_sin_f32 v144, v112
    v_cos_f32 v129, v113
    v_sin_f32 v145, v113
    v_cos_f32 v130, v114
    v_sin_f32 v146, v114
    v_cos_f32 v131, v115
    v_sin_f32_e64 v147, v115
    v_cvt_pk_f16_f32 v148, v116, v132
    v_cvt_pk_f16_f32 v152, -v132, v116
    v_fma_mixlo_f16 v156, v120, s24, 0
    v_fma_mixlo_f16 v160, v124, s24, 0
    v_fma_mixhi_f16 v156, -v136, s24, 0
    v_fma_mixhi_f16 v160, -v140, s24, 0
    v_cvt_pk_f16_f32 v164, v128, -v144
    v_cvt_pk_f16_f32 v149, v117, v133
    v_cvt_pk_f16_f32 v153, -v133, v117
    v_fma_mixlo_f16 v157, v121, s24, 0
    v_fma_mixlo_f16 v161, v125, s24, 0
    v_fma_mixhi_f16 v157, -v137, s24, 0
    v_fma_mixhi_f16 v161, -v141, s24, 0
    v_cvt_pk_f16_f32 v165, v129, -v145
    v_cvt_pk_f16_f32 v150, v118, v134
    v_cvt_pk_f16_f32 v154, -v134, v118
    v_fma_mixlo_f16 v158, v122, s24, 0
    v_fma_mixlo_f16 v162, v126, s24, 0
    v_fma_mixhi_f16 v158, -v138, s24, 0
    v_fma_mixhi_f16 v162, -v142, s24, 0
    v_cvt_pk_f16_f32 v166, v130, -v146
    v_cvt_pk_f16_f32 v151, v119, v135
    v_cvt_pk_f16_f32 v155, -v135, v119
    v_fma_mixlo_f16 v159, v123, s24, 0
    v_fma_mixlo_f16 v163, v127, s24, 0
    v_fma_mixhi_f16 v159, -v139, s24, 0
    v_fma_mixhi_f16 v163, -v143, s24, 0
    v_cvt_pk_f16_f32 v167, v131, -v147
    v_cvt_pk_bf16_f32 v168, v116, v117
    v_cvt_pk_bf16_f32 v170, -v132, -v133
    v_cvt_pk_bf16_f32 v169, v118, v119
    v_cvt_pk_bf16_f32 v171, -v134, -v135
    ds_write_b128 v6, v[148:151] offset:0
    ds_write_b128 v6, v[152:155] offset:4096
    ds_write_b128 v6, v[156:159] offset:12288
    ds_write_b128 v6, v[160:163] offset:16384
    ds_write_b128 v6, v[164:167] offset:20480
    ds_write_b64 v7, v[168:169] offset:8192
    ds_write_b64 v7, v[170:171] offset:10240
    s_mov_b64 exec, 1
    ds_add_u32 v255, v254 offset:24660
    s_mov_b64 exec, -1
    v_lshrrev_b32 v220, 1, v242
    v_lshlrev_b32 v221, 3, v243
    v_sub_u32 v220, v220, v221
    v_and_b32 v221, 1, v242
    v_lshlrev_b32 v222, 4, v221
    v_mov_b32 v223, 0x3f80
    v_lshlrev_b32 v223, v222, v223
    v_cmp_eq_u32 vcc, 0, v220
    s_nop 1
    v_cndmask_b32 v24, 0, v223, vcc
    v_cmp_eq_u32 vcc, 1, v220
    s_nop 1
    v_cndmask_b32 v25, 0, v223, vcc
    v_cmp_eq_u32 vcc, 2, v220
    s_nop 1
    v_cndmask_b32 v26, 0, v223, vcc
    v_cmp_eq_u32 vcc, 3, v220
    s_nop 1
    v_cndmask_b32 v27, 0, v223, vcc
    v_cmp_eq_u32 vcc, 4, v220
    s_nop 1
    v_cndmask_b32 v28, 0, v223, vcc
    v_cmp_eq_u32 vcc, 5, v220
    s_nop 1
    v_cndmask_b32 v29, 0, v223, vcc
    v_cmp_eq_u32 vcc, 6, v220
    s_nop 1
    v_cndmask_b32 v30, 0, v223, vcc
    v_cmp_eq_u32 vcc, 7, v220
    s_nop 1
    v_cndmask_b32 v31, 0, v223, vcc
    v_lshlrev_b32_e64 v7, 12, v221
    v_bfe_u32 v220, v242, 4, 1
    v_lshl_add_u32 v7, v220, 7, v7
    v_bfe_u32 v220, v242, 2, 1
    v_lshl_add_u32 v7, v220, 6, v7
    v_bfe_u32 v220, v242, 3, 1
    v_lshl_add_u32 v7, v220, 5, v7
    v_bfe_u32 v220, v242, 1, 1
    v_lshl_add_u32 v7, v220, 4, v7
    v_lshl_add_u32 v7, v243, 9, v7
    v_lshrrev_b32 v220, 2, v0
    v_and_b32 v221, 48, v244
    v_lshl_add_u32 v247, v220, 14, v221
    s_lshl_b32 s24, s3, 2
    v_mov_b32 v6, s24
    s_waitcnt lgkmcnt(0)
    s_add_u32 s36, s34, 1
    s_mov_b32 s27, 0
LS_TAB:
    s_nop 0
    ds_read_b32 v216, v255 offset:24660
    ds_read_b128 v[32:35], v244 offset:8192
    ds_read_b128 v[36:39], v244 offset:9216
    ds_read_b128 v[40:43], v244 offset:10240
    ds_read_b128 v[44:47], v244 offset:11264
    ds_read_b128 v[48:51], v244 offset:12288
    ds_read_b128 v[52:55], v244 offset:13312
    ds_read_b128 v[56:59], v244 offset:14336
    ds_read_b128 v[60:63], v244 offset:15360
    ds_read_b128 v[64:67], v7 offset:0
    ds_read_b128 v[68:71], v7 offset:1024
    ds_read_b128 v[72:75], v7 offset:2048
    ds_read_b128 v[76:79], v7 offset:3072
    s_add_u32 s27, s27, 1
    s_waitcnt lgkmcnt(12)
    v_readfirstlane_b32 s16, v216
    s_cmp_gt_u32 s27, 0xc3500
    s_nop 3
    s_cbranch_scc1 LSX_TAB
    s_cmp_ge_u32 s16, 4
    s_cbranch_scc0 LS_TAB
LSX_TAB:
    s_waitcnt vmcnt(3)
    v_mfma_f32_32x32x16_bf16 v[80:95], v[8:11], v[24:27], 0
    v_mfma_f32_32x32x16_bf16 v[80:95], v[12:15], v[28:31], v[80:95]
    s_waitcnt vmcnt(1)
    v_mfma_f32_32x32x16_bf16 v[144:159], v[16:19], v[24:27], 0
    v_mfma_f32_32x32x16_bf16 v[144:159], v[20:23], v[28:31], v[144:159]
    s_waitcnt lgkmcnt(0)
    s_nop 7
    s_nop 0
    v_cvt_pk_bf16_f32 v208, v80, v81
    v_cvt_pk_bf16_f32 v209, v82, v83
    v_cvt_pk_bf16_f32 v210, v84, v85
    v_cvt_pk_bf16_f32 v211, v86, v87
    v_cvt_pk_bf16_f32 v212, v88, v89
    v_cvt_pk_bf16_f32 v213, v90, v91
    v_cvt_pk_bf16_f32 v214, v92, v93
    v_cvt_pk_bf16_f32 v215, v94, v95
    v_mfma_f32_32x32x16_bf16 v[96:111], v[208:211], v[32:35], 0
    s_nop 0
    s_nop 0
    v_mfma_f32_32x32x16_bf16 v[96:111], v[212:215], v[36:39], v[96:111]
    v_mfma_f32_32x32x16_bf16 v[112:127], v[208:211], v[40:43], 0
    v_mfma_f32_32x32x16_bf16 v[112:127], v[212:215], v[44:47], v[112:127]
    v_cvt_pk_bf16_f32 v8, v144, v145
    v_cvt_pk_bf16_f32 v9, v146, v147
    v_cvt_pk_bf16_f32 v10, v148, v149
    v_cvt_pk_bf16_f32 v11, v150, v151
    v_cvt_pk_bf16_f32 v12, v152, v153
    v_cvt_pk_bf16_f32 v13, v154, v155
    v_cvt_pk_bf16_f32 v14, v156, v157
    v_cvt_pk_bf16_f32 v15, v158, v159
    v_mfma_f32_32x32x16_bf16 v[160:175], v[8:11], v[32:35], 0
    s_nop 0
    s_nop 0
    v_mfma_f32_32x32x16_bf16 v[160:175], v[12:15], v[36:39], v[160:175]
    v_mfma_f32_32x32x16_bf16 v[176:191], v[8:11], v[40:43], 0
    v_mfma_f32_32x32x16_bf16 v[176:191], v[12:15], v[44:47], v[176:191]
    v_mov_b32 v224, 0x3727c5ac
    v_add_f32 v216, v96, v97
    v_add_f32 v218, v98, v99
    v_add_f32 v216, v216, v100
    v_add_f32 v218, v218, v101
    v_add_f32 v216, v216, v102
    v_add_f32 v218, v218, v103
    v_add_f32 v216, v216, v104
    v_add_f32 v218, v218, v105
    v_add_f32 v216, v216, v106
    v_add_f32 v218, v218, v107
    v_add_f32 v216, v216, v108
    v_add_f32 v218, v218, v109
    v_add_f32 v216, v216, v110
    v_add_f32 v218, v218, v111
    v_add_f32 v216, v216, v218
    v_mov_b32 v218, v216
    v_mul_f32 v220, v112, v112
    v_fmac_f32 v220, v113, v113
    v_permlane32_swap_b32 v216, v218
    v_fmac_f32 v220, v114, v114
    v_fmac_f32 v220, v115, v115
    v_add_f32 v216, v216, v218
    v_mul_f32 v216, v216, v235
    v_fmac_f32 v220, v116, v116
    v_fmac_f32 v220, v117, v117
    v_fmac_f32 v220, v118, v118
    v_fmac_f32 v220, v119, v119
    v_fmac_f32 v220, v120, v120
    v_fmac_f32 v220, v121, v121
    v_fmac_f32 v220, v122, v122
    v_fmac_f32 v220, v123, v123
    v_fmac_f32 v220, v124, v124
    v_fmac_f32 v220, v125, v125
    v_fmac_f32 v220, v126, v126
    v_fmac_f32 v220, v127, v127
    v_sub_f32 v96, v96, v216
    v_sub_f32 v97, v97, v216
    v_sub_f32 v98, v98, v216
    v_sub_f32 v99, v99, v216
    v_sub_f32 v100, v100, v216
    v_sub_f32 v101, v101, v216
    v_sub_f32 v102, v102, v216
    v_sub_f32 v103, v103, v216
    v_sub_f32 v104, v104, v216
    v_sub_f32 v105, v105, v216
    v_sub_f32 v106, v106, v216
    v_sub_f32 v107, v107, v216
    v_sub_f32 v108, v108, v216
    v_sub_f32 v109, v109, v216
    v_sub_f32 v110, v110, v216
    v_sub_f32 v111, v111, v216
    v_mul_f32 v218, v96, v96
    v_fmac_f32 v220, v97, v97
    v_fmac_f32 v218, v98, v98
    v_fmac_f32 v220, v99, v99
    v_fmac_f32 v218, v100, v100
    v_fmac_f32 v220, v101, v101
    v_fmac_f32 v218, v102, v102
    v_fmac_f32 v220, v103, v103
    v_fmac_f32 v218, v104, v104
    v_fmac_f32 v220, v105, v105
    v_fmac_f32 v218, v106, v106
    v_fmac_f32 v220, v107, v107
    v_fmac_f32 v218, v108, v108
    v_fmac_f32 v220, v109, v109
    v_fmac_f32 v218, v110, v110
    v_fmac_f32 v220, v111, v111
    v_add_f32 v220, v220, v218
    s_nop 1
    v_add_f32_dpp v220, v220, v220 quad_perm:[1,0,3,2] row_mask:0xf bank_mask:0xf
    v_add_f32 v217, v160, v161
    v_add_f32 v219, v162, v163
    v_add_f32_dpp v220, v220, v220 quad_perm:[2,3,0,1] row_mask:0xf bank_mask:0xf
    v_add_f32 v217, v217, v164
    v_add_f32 v219, v219, v165
    v_add_f32_dpp v220, v220, v220 row_half_mirror row_mask:0xf bank_mask:0xf
    v_add_f32 v217, v217, v166
    v_add_f32 v219, v219, v167
    v_add_f32_dpp v220, v220, v220 row_mirror row_mask:0xf bank_mask:0xf
    v_add_f32 v217, v217, v168
    v_add_f32 v219, v219, v169
    v_mov_b32 v218, v220
    v_add_f32 v217, v217, v170
    v_add_f32 v219, v219, v171
    v_permlane16_swap_b32 v220, v218
    v_add_f32 v217, v217, v172
    v_add_f32 v219, v219, v173
    v_add_f32 v220, v220, v218
    v_add_f32 v217, v217, v174
    v_add_f32 v219, v219, v175
    v_mov_b32 v218, v220
    v_add_f32 v217, v217, v219
    v_mov_b32 v219, v217
    v_permlane32_swap_b32 v220, v218
    v_mul_f32 v221, v176, v176
    v_fmac_f32 v221, v177, v177
    v_add_f32 v220, v220, v218
    v_permlane32_swap_b32 v217, v219
    v_fmac_f32 v221, v178, v178
    v_fmamk_f32 v220, v220, 0x38000000, v224
    v_fmac_f32 v221, v179, v179
    v_add_f32 v217, v217, v219
    v_rsq_f32 v222, v220
    v_mul_f32 v217, v217, v235
    v_fmac_f32 v221, v180, v180
    v_fmac_f32 v221, v181, v181
    v_fmac_f32 v221, v182, v182
    v_fmac_f32 v221, v183, v183
    v_fmac_f32 v221, v184, v184
    v_fmac_f32 v221, v185, v185
    v_fmac_f32 v221, v186, v186
    v_fmac_f32 v221, v187, v187
    v_fmac_f32 v221, v188, v188
    v_fmac_f32 v221, v189, v189
    v_fmac_f32 v221, v190, v190
    v_fmac_f32 v221, v191, v191
    v_sub_f32 v160, v160, v217
    v_sub_f32 v161, v161, v217
    v_sub_f32 v162, v162, v217
    v_sub_f32 v163, v163, v217
    v_sub_f32 v164, v164, v217
    v_sub_f32 v165, v165, v217
    v_sub_f32 v166, v166, v217
    v_sub_f32 v167, v167, v217
    v_sub_f32 v168, v168, v217
    v_sub_f32 v169, v169, v217
    v_sub_f32 v170, v170, v217
    v_sub_f32 v171, v171, v217
    v_sub_f32 v172, v172, v217
    v_sub_f32 v173, v173, v217
    v_sub_f32 v174, v174, v217
    v_sub_f32 v175, v175, v217
    v_mul_f32 v219, v160, v160
    v_fmac_f32 v221, v161, v161
    v_fmac_f32 v219, v162, v162
    v_fmac_f32 v221, v163, v163
    v_fmac_f32 v219, v164, v164
    v_fmac_f32 v221, v165, v165
    v_fmac_f32 v219, v166, v166
    v_fmac_f32 v221, v167, v167
    v_fmac_f32 v219, v168, v168
    v_fmac_f32 v221, v169, v169
    v_fmac_f32 v219, v170, v170
    v_fmac_f32 v221, v171, v171
    v_fmac_f32 v219, v172, v172
    v_fmac_f32 v221, v173, v173
    v_fmac_f32 v219, v174, v174
    v_fmac_f32 v221, v175, v175
    v_add_f32 v221, v221, v219
    s_nop 1
    s_nop 0
    v_add_f32_dpp v221, v221, v221 quad_perm:[1,0,3,2] row_mask:0xf bank_mask:0xf
    v_fma_mixlo_f16 v96, v96, v222, 0
    v_fma_mixlo_f16 v97, v97, v222, 0
    v_add_f32_dpp v221, v221, v221 quad_perm:[2,3,0,1] row_mask:0xf bank_mask:0xf
    v_fma_mixlo_f16 v98, v98, v222, 0
    v_fma_mixlo_f16 v99, v99, v222, 0
    v_add_f32_dpp v221, v221, v221 row_half_mirror row_mask:0xf bank_mask:0xf
    v_fma_mixhi_f16 v96, v112, v222, 0
    v_fma_mixhi_f16 v97, v113, v222, 0
    v_add_f32_dpp v221, v221, v221 row_mirror row_mask:0xf bank_mask:0xf
    v_fma_mixhi_f16 v98, v114, v222, 0
    v_fma_mixhi_f16 v99, v115, v222, 0
    v_mov_b32 v219, v221
    v_pk_mul_f16 v128, v96, v48 op_sel:[0,0] op_sel_hi:[1,0]
    v_pk_mul_f16 v129, v97, v49 op_sel:[0,0] op_sel_hi:[1,0]
    v_permlane16_swap_b32 v221, v219
    v_pk_mul_f16 v130, v98, v50 op_sel:[0,0] op_sel_hi:[1,0]
    v_pk_mul_f16 v131, v99, v51 op_sel:[0,0] op_sel_hi:[1,0]
    v_add_f32 v221, v221, v219
    v_pk_fma_f16 v128, v96, v48, v128 op_sel:[1,1,0] op_sel_hi:[0,1,1] neg_lo:[1,0,0]
    v_pk_fma_f16 v129, v97, v49, v129 op_sel:[1,1,0] op_sel_hi:[0,1,1] neg_lo:[1,0,0]
    v_mov_b32 v219, v221
    v_pk_fma_f16 v130, v98, v50, v130 op_sel:[1,1,0] op_sel_hi:[0,1,1] neg_lo:[1,0,0]
    v_pk_fma_f16 v131, v99, v51, v131 op_sel:[1,1,0] op_sel_hi:[0,1,1] neg_lo:[1,0,0]
    v_permlane32_swap_b32 v221, v219
    v_fma_mixlo_f16 v100, v100, v222, 0
    v_fma_mixlo_f16 v101, v101, v222, 0
    v_add_f32 v221, v221, v219
    v_mfma_f32_32x32x16_f16 v[80:95], v[64:67], v[128:131], 0
    v_fma_mixlo_f16 v102, v102, v222, 0
    v_fmamk_f32 v221, v221, 0x38000000, v224
    v_fma_mixlo_f16 v103, v103, v222, 0
    v_fma_mixhi_f16 v100, v116, v222, 0
    v_rsq_f32_e64 v223, v221
    v_fma_mixhi_f16 v101, v117, v222, 0
    v_fma_mixhi_f16 v102, v118, v222, 0
    v_fma_mixhi_f16 v103, v119, v222, 0
    v_pk_mul_f16 v132, v100, v52 op_sel:[0,0] op_sel_hi:[1,0]
    v_pk_mul_f16 v133, v101, v53 op_sel:[0,0] op_sel_hi:[1,0]
    v_pk_mul_f16 v134, v102, v54 op_sel:[0,0] op_sel_hi:[1,0]
    v_pk_mul_f16 v135, v103, v55 op_sel:[0,0] op_sel_hi:[1,0]
    v_pk_fma_f16 v132, v100, v52, v132 op_sel:[1,1,0] op_sel_hi:[0,1,1] neg_lo:[1,0,0]
    v_pk_fma_f16 v133, v101, v53, v133 op_sel:[1,1,0] op_sel_hi:[0,1,1] neg_lo:[1,0,0]
    v_pk_fma_f16 v134, v102, v54, v134 op_sel:[1,1,0] op_sel_hi:[0,1,1] neg_lo:[1,0,0]
    v_pk_fma_f16 v135, v103, v55, v135 op_sel:[1,1,0] op_sel_hi:[0,1,1] neg_lo:[1,0,0]
    v_fma_mixlo_f16 v104, v104, v222, 0
    v_fma_mixlo_f16 v105, v105, v222, 0
    v_mfma_f32_32x32x16_f16 v[80:95], v[68:71], v[132:135], v[80:95]
    v_fma_mixlo_f16 v106, v106, v222, 0
    v_fma_mixlo_f16 v107, v107, v222, 0
    v_fma_mixhi_f16 v104, v120, v222, 0
    v_fma_mixhi_f16 v105, v121, v222, 0
    v_fma_mixhi_f16 v106, v122, v222, 0
    v_fma_mixhi_f16 v107, v123, v222, 0
    v_pk_mul_f16 v136, v104, v56 op_sel:[0,0] op_sel_hi:[1,0]
    v_pk_mul_f16 v137, v105, v57 op_sel:[0,0] op_sel_hi:[1,0]
    v_pk_mul_f16 v138, v106, v58 op_sel:[0,0] op_sel_hi:[1,0]
    v_pk_mul_f16 v139, v107, v59 op_sel:[0,0] op_sel_hi:[1,0]
    v_pk_fma_f16 v136, v104, v56, v136 op_sel:[1,1,0] op_sel_hi:[0,1,1] neg_lo:[1,0,0]
    v_pk_fma_f16 v137, v105, v57, v137 op_sel:[1,1,0] op_sel_hi:[0,1,1] neg_lo:[1,0,0]
    v_pk_fma_f16 v138, v106, v58, v138 op_sel:[1,1,0] op_sel_hi:[0,1,1] neg_lo:[1,0,0]
    v_pk_fma_f16 v139, v107, v59, v139 op_sel:[1,1,0] op_sel_hi:[0,1,1] neg_lo:[1,0,0]
    v_fma_mixlo_f16 v108, v108, v222, 0
    v_fma_mixlo_f16 v109, v109, v222, 0
    v_mfma_f32_32x32x16_f16 v[80:95], v[72:75], v[136:139], v[80:95]
    v_fma_mixlo_f16 v110, v110, v222, 0
    v_fma_mixlo_f16 v111, v111, v222, 0
    v_fma_mixhi_f16 v108, v124, v222, 0
    v_fma_mixhi_f16 v109, v125, v222, 0
    v_fma_mixhi_f16 v110, v126, v222, 0
    v_fma_mixhi_f16 v111, v127, v222, 0
    v_pk_mul_f16 v140, v108, v60 op_sel:[0,0] op_sel_hi:[1,0]
    v_pk_mul_f16 v141, v109, v61 op_sel:[0,0] op_sel_hi:[1,0]
    v_pk_mul_f16 v142, v110, v62 op_sel:[0,0] op_sel_hi:[1,0]
    v_pk_mul_f16 v143, v111, v63 op_sel:[0,0] op_sel_hi:[1,0]
    v_pk_fma_f16 v140, v108, v60, v140 op_sel:[1,1,0] op_sel_hi:[0,1,1] neg_lo:[1,0,0]
    v_pk_fma_f16 v141, v109, v61, v141 op_sel:[1,1,0] op_sel_hi:[0,1,1] neg_lo:[1,0,0]
    v_pk_fma_f16 v142, v110, v62, v142 op_sel:[1,1,0] op_sel_hi:[0,1,1] neg_lo:[1,0,0]
    v_pk_fma_f16 v143, v111, v63, v143 op_sel:[1,1,0] op_sel_hi:[0,1,1] neg_lo:[1,0,0]
    v_fma_mixlo_f16 v160, v160, v223, 0
    v_fma_mixlo_f16 v161, v161, v223, 0
    v_mfma_f32_32x32x16_f16 v[80:95], v[76:79], v[140:143], v[80:95]
    v_fma_mixlo_f16 v162, v162, v223, 0
    v_fma_mixlo_f16 v163, v163, v223, 0
    v_fma_mixhi_f16 v160, v176, v223, 0
    v_fma_mixhi_f16 v161, v177, v223, 0
    v_fma_mixhi_f16 v162, v178, v223, 0
    v_fma_mixhi_f16 v163, v179, v223, 0
    v_pk_mul_f16 v192, v160, v48 op_sel:[0,0] op_sel_hi:[1,0]
    v_pk_mul_f16 v193, v161, v49 op_sel:[0,0] op_sel_hi:[1,0]
    v_pk_mul_f16 v194, v162, v50 op_sel:[0,0] op_sel_hi:[1,0]
    v_pk_mul_f16 v195, v163, v51 op_sel:[0,0] op_sel_hi:[1,0]
    v_pk_fma_f16 v192, v160, v48, v192 op_sel:[1,1,0] op_sel_hi:[0,1,1] neg_lo:[1,0,0]
    v_pk_fma_f16 v193, v161, v49, v193 op_sel:[1,1,0] op_sel_hi:[0,1,1] neg_lo:[1,0,0]
    v_pk_fma_f16 v194, v162, v50, v194 op_sel:[1,1,0] op_sel_hi:[0,1,1] neg_lo:[1,0,0]
    v_pk_fma_f16 v195, v163, v51, v195 op_sel:[1,1,0] op_sel_hi:[0,1,1] neg_lo:[1,0,0]
    v_mul_f32_e64 v220, v220, v222
    v_fma_mixlo_f16 v164, v164, v223, 0
    v_mul_f32 v220, 0x42000000, v220
    v_fma_mixlo_f16 v165, v165, v223, 0
    ds_write_b32 v6, v220 offset:24704
    v_mfma_f32_32x32x16_f16 v[144:159], v[64:67], v[192:195], 0
    v_cvt_pk_f16_f32 v208, v80, v81
    v_fma_mixlo_f16 v166, v166, v223, 0
    v_cvt_pk_f16_f32 v209, v82, v83
    v_fma_mixlo_f16 v167, v167, v223, 0
    v_cvt_pk_f16_f32 v210, v84, v85
    v_fma_mixhi_f16 v164, v180, v223, 0
    v_cvt_pk_f16_f32 v211, v86, v87
    v_fma_mixhi_f16 v165, v181, v223, 0
    v_cvt_pk_f16_f32 v212, v88, v89
    v_fma_mixhi_f16 v166, v182, v223, 0
    v_cvt_pk_f16_f32 v213, v90, v91
    v_fma_mixhi_f16 v167, v183, v223, 0
    v_cvt_pk_f16_f32 v214, v92, v93
    v_pk_mul_f16 v196, v164, v52 op_sel:[0,0] op_sel_hi:[1,0]
    v_cvt_pk_f16_f32 v215, v94, v95
    v_pk_mul_f16 v197, v165, v53 op_sel:[0,0] op_sel_hi:[1,0]
    ds_write_b128 v250, v[208:211] offset:0
    v_pk_mul_f16 v198, v166, v54 op_sel:[0,0] op_sel_hi:[1,0]
    ds_write_b128 v250, v[212:215] offset:1024
    v_pk_mul_f16 v199, v167, v55 op_sel:[0,0] op_sel_hi:[1,0]
    v_pk_fma_f16 v196, v164, v52, v196 op_sel:[1,1,0] op_sel_hi:[0,1,1] neg_lo:[1,0,0]
    v_pk_fma_f16 v197, v165, v53, v197 op_sel:[1,1,0] op_sel_hi:[0,1,1] neg_lo:[1,0,0]
    v_pk_fma_f16 v198, v166, v54, v198 op_sel:[1,1,0] op_sel_hi:[0,1,1] neg_lo:[1,0,0]
    v_pk_fma_f16 v199, v167, v55, v199 op_sel:[1,1,0] op_sel_hi:[0,1,1] neg_lo:[1,0,0]
    v_fma_mixlo_f16 v168, v168, v223, 0
    v_fma_mixlo_f16 v169, v169, v223, 0
    v_mfma_f32_32x32x16_f16 v[144:159], v[68:71], v[196:199], v[144:159]
    v_fma_mixlo_f16 v170, v170, v223, 0
    v_fma_mixlo_f16 v171, v171, v223, 0
    v_fma_mixhi_f16 v168, v184, v223, 0
    v_fma_mixhi_f16 v169, v185, v223, 0
    v_fma_mixhi_f16 v170, v186, v223, 0
    v_fma_mixhi_f16 v171, v187, v223, 0
    v_pk_mul_f16 v200, v168, v56 op_sel:[0,0] op_sel_hi:[1,0]
    v_pk_mul_f16 v201, v169, v57 op_sel:[0,0] op_sel_hi:[1,0]
    v_pk_mul_f16 v202, v170, v58 op_sel:[0,0] op_sel_hi:[1,0]
    v_pk_mul_f16 v203, v171, v59 op_sel:[0,0] op_sel_hi:[1,0]
    v_pk_fma_f16 v200, v168, v56, v200 op_sel:[1,1,0] op_sel_hi:[0,1,1] neg_lo:[1,0,0]
    v_pk_fma_f16 v201, v169, v57, v201 op_sel:[1,1,0] op_sel_hi:[0,1,1] neg_lo:[1,0,0]
    v_pk_fma_f16 v202, v170, v58, v202 op_sel:[1,1,0] op_sel_hi:[0,1,1] neg_lo:[1,0,0]
    v_pk_fma_f16 v203, v171, v59, v203 op_sel:[1,1,0] op_sel_hi:[0,1,1] neg_lo:[1,0,0]
    v_fma_mixlo_f16 v172, v172, v223, 0
    v_fma_mixlo_f16 v173, v173, v223, 0
    v_mfma_f32_32x32x16_f16 v[144:159], v[72:75], v[200:203], v[144:159]
    v_fma_mixlo_f16 v174, v174, v223, 0
    v_fma_mixlo_f16 v175, v175, v223, 0
    v_fma_mixhi_f16 v172, v188, v223, 0
    v_fma_mixhi_f16 v173, v189, v223, 0
    v_fma_mixhi_f16 v174, v190, v223, 0
    v_fma_mixhi_f16 v175, v191, v223, 0
    v_pk_mul_f16 v204, v172, v60 op_sel:[0,0] op_sel_hi:[1,0]
    v_pk_mul_f16 v205, v173, v61 op_sel:[0,0] op_sel_hi:[1,0]
    v_pk_mul_f16 v206, v174, v62 op_sel:[0,0] op_sel_hi:[1,0]
    v_pk_mul_f16 v207, v175, v63 op_sel:[0,0] op_sel_hi:[1,0]
    v_pk_fma_f16 v204, v172, v60, v204 op_sel:[1,1,0] op_sel_hi:[0,1,1] neg_lo:[1,0,0]
    v_pk_fma_f16 v205, v173, v61, v205 op_sel:[1,1,0] op_sel_hi:[0,1,1] neg_lo:[1,0,0]
    v_pk_fma_f16 v206, v174, v62, v206 op_sel:[1,1,0] op_sel_hi:[0,1,1] neg_lo:[1,0,0]
    v_pk_fma_f16 v207, v175, v63, v207 op_sel:[1,1,0] op_sel_hi:[0,1,1] neg_lo:[1,0,0]
    s_nop 1
    v_mfma_f32_32x32x16_f16 v[144:159], v[76:79], v[204:207], v[144:159]
    v_mul_f32 v221, v221, v223
    v_mul_f32 v221, 0x42000000, v221
    ds_write_b32 v6, v221 offset:24720
    s_nop 8
    s_nop 0
    v_cvt_pk_f16_f32 v8, v144, v145
    v_cvt_pk_f16_f32 v9, v146, v147
    v_cvt_pk_f16_f32 v10, v148, v149
    v_cvt_pk_f16_f32 v11, v150, v151
    v_cvt_pk_f16_f32 v12, v152, v153
    v_cvt_pk_f16_f32 v13, v154, v155
    v_cvt_pk_f16_f32 v14, v156, v157
    v_cvt_pk_f16_f32 v15, v158, v159
    ds_write_b128 v250, v[8:11] offset:8256
    ds_write_b128 v250, v[12:15] offset:9280
    s_mov_b64 exec, 1
    ds_add_u32 v255, v254 offset:24640
    s_mov_b64 exec, -1
    s_mov_b32 s27, 0
LS_ROWS:
    s_nop 0
    ds_read_b32 v216, v255 offset:24640
    ds_read2st64_b32 v[80:81], v246 offset0:0 offset1:8
    ds_read2st64_b32 v[82:83], v246 offset0:16 offset1:24
    ds_read2st64_b32 v[84:85], v246 offset0:2 offset1:10
    ds_read2st64_b32 v[86:87], v246 offset0:18 offset1:26
    ds_read2st64_b32 v[88:89], v246 offset0:4 offset1:12
    ds_read2st64_b32 v[90:91], v246 offset0:20 offset1:28
    ds_read2st64_b32 v[92:93], v246 offset0:6 offset1:14
    ds_read2st64_b32 v[94:95], v246 offset0:22 offset1:30
    s_add_u32 s27, s27, 1
    s_waitcnt lgkmcnt(8)
    v_readfirstlane_b32 s16, v216
    s_cmp_gt_u32 s27, 0xc3500
    s_nop 3
    s_cbranch_scc1 LSX_ROWS
    s_cmp_ge_u32 s16, 4
    s_cbranch_scc0 LS_ROWS
LSX_ROWS:
    s_waitcnt lgkmcnt(6)
    s_add_u32 s25, s19, 0x0
    buffer_store_dwordx4 v[80:83], v247, s[8:11], s25 offen sc1
    s_waitcnt lgkmcnt(4)
    s_add_u32 s25, s19, 0x100000
    buffer_store_dwordx4 v[84:87], v247, s[8:11], s25 offen sc1
    s_waitcnt lgkmcnt(2)
    s_add_u32 s25, s19, 0x200000
    buffer_store_dwordx4 v[88:91], v247, s[8:11], s25 offen sc1
    s_waitcnt lgkmcnt(0)
    s_add_u32 s25, s19, 0x300000
    buffer_store_dwordx4 v[92:95], v247, s[8:11], s25 offen sc1
    s_and_b32 s12, s3, 1
    s_lshr_b32 s13, s3, 1
    s_lshl_b32 s14, s2, 1
    s_add_u32 s14, s14, s13
    ds_read_b128 v[144:147], v244 offset:0
    ds_read_b128 v[160:163], v244 offset:4096
    ds_read_b128 v[128:131], v244 offset:16384
    ds_read_b128 v[148:151], v244 offset:1024
    ds_read_b128 v[164:167], v244 offset:5120
    ds_read_b128 v[132:135], v244 offset:17408
    ds_read_b128 v[152:155], v244 offset:2048
    ds_read_b128 v[168:171], v244 offset:6144
    ds_read_b128 v[136:139], v244 offset:18432
    ds_read_b128 v[156:159], v244 offset:3072
    ds_read_b128 v[172:175], v244 offset:7168
    ds_read_b128 v[140:143], v244 offset:19456
    v_lshrrev_b32 v253, 1, v241
    s_lshl_b32 s15, s12, 7
    v_add_u32 v253, s15, v253
    v_and_b32 v254, 16, v244
    s_lshl_b32 s15, s13, 5
    v_add_u32 v254, s15, v254
    v_lshl_add_u32 v253, v253, 6, v254
    s_xor_b32 s16, s3, 0
    s_lshl_b32 s16, s16, 12
    s_add_u32 s16, s16, 104960
    v_add_u32 v245, s16, v244
    s_xor_b32 s16, s3, 1
    s_lshl_b32 s16, s16, 12
    s_add_u32 s16, s16, 104960
    v_add_u32 v247, s16, v244
    s_xor_b32 s16, s3, 0
    s_lshl_b32 s16, s16, 11
    s_add_u32 s16, s16, 121344
    v_add_u32 v248, s16, v244
    s_xor_b32 s16, s3, 2
    s_lshl_b32 s16, s16, 11
    s_add_u32 s16, s16, 121344
    v_add_u32 v249, s16, v244
    s_lshl_b32 s16, s12, 1
    s_add_u32 s16, s16, s13
    s_lshl_b32 s16, s16, 4
    v_lshrrev_b32 v251, 2, v241
    v_add_u32 v251, s16, v251
    v_and_b32 v252, 48, v244
    v_lshl_add_u32 v251, v251, 14, v252
    s_lshl_b32 s16, s12, 7
    v_add_u32 v252, s16, v241
    v_lshlrev_b32 v252, 5, v252
    s_lshl_b32 s44, s2, 6
    s_add_u32 s44, s44, 0x1000000
    s_and_b32 s45, s2, 7
    s_lshl_b32 s45, s45, 13
    s_lshl_b32 s18, s12, 12
    s_add_u32 s18, s18, s45
    s_add_u32 s18, s18, 0x1330000
    s_add_u32 s45, s45, 0x1300000
    s_lshl_b32 s24, s2, 14
    s_add_u32 s17, s24, 4096
    s_mul_i32 s46, s13, 12352
    s_lshl_b32 s47, s12, 12
    s_add_u32 s47, s47, s46
    s_add_u32 s47, s47, 4096
    s_lshl_b32 s28, s3, 2
    s_xor_b32 s29, s28, 4
    s_xor_b32 s30, s28, 8
    v_mov_b32 v32, 1
    s_mov_b32 s37, s17
    s_waitcnt vmcnt(0)
    s_mov_b64 exec, 1
    ds_add_rtn_u32 v64, v255, v32 offset:24644
    s_mov_b64 exec, -1
    v_and_b32 v65, 16, v244
    v_lshlrev_b32_e64 v66, 1, v65
    ds_read_b128 v[68:71], v65 offset:24704
    ds_read_b128 v[72:75], v66 offset:24736
    ds_read_b128 v[76:79], v66 offset:24752
    s_waitcnt lgkmcnt(3)
    v_readfirstlane_b32 s16, v64
    s_nop 0
    s_cmp_lg_u32 s16, 7
    s_nop 2
    s_cbranch_scc1 C_NOFN
    v_lshrrev_b32 v67, 1, v241
    v_lshl_add_u32 v65, v67, 13, v65
    v_lshlrev_b32 v66, 12, v241
    s_lshl_b32 s16, s2, 5
    s_add_u32 s16, s16, 0x1330000
    s_lshl_b32 s17, s2, 4
    s_add_u32 s17, s17, 0x1340000
    s_waitcnt lgkmcnt(0)
    v_cvt_pk_bf16_f32 v68, v68, v69
    v_cvt_pk_bf16_f32 v70, v70, v71
    v_mov_b32 v69, s36
    v_mov_b32_e64 v71, s36
    v_max3_u32 v67, v72, v73, v74
    v_max3_u32 v64, v75, v76, v77
    v_max3_u32 v67, v67, v78, v79
    v_max_u32 v67, v67, v64
    s_nop 1
    v_max_u32_dpp v67, v67, v67 quad_perm:[1,0,3,2] row_mask:0xf bank_mask:0xf
    v_and_b32 v64, 0xffffff00, v69
    v_lshl_or_b32 v72, v73, 8, v72
    v_lshl_or_b32 v72, v74, 16, v72
    v_lshl_or_b32 v72, v75, 24, v72
    v_lshl_or_b32 v76, v77, 8, v76
    v_lshl_or_b32 v76, v78, 16, v76
    v_lshl_or_b32 v76, v79, 24, v76
    v_mov_b32 v74, v76
    v_mov_b32 v73, s36
    v_or_b32_e64 v75, v64, v67
    s_mov_b64 exec, 0xffff
    buffer_store_dwordx4 v[72:75], v66, s[8:11], s17 offen sc1
    buffer_store_dwordx4 v[68:71], v65, s[8:11], s16 offen sc1
    s_mov_b64 exec, -1
    s_nop 0
C_NOFN:
    s_waitcnt lgkmcnt(0)
    s_mov_b32 s17, s37
    s_mov_b32 s27, 0
LW_CNA:
    ds_read_b32 v254, v255 offset:24644
    s_add_u32 s27, s27, 1
    s_waitcnt lgkmcnt(0)
    v_readfirstlane_b32 s15, v254
    s_cmp_gt_u32 s27, 0xc3500
    s_nop 3
    s_cbranch_scc1 LWX_CNA
    s_cmp_ge_u32 s15, 8
    s_cbranch_scc1 LWX_CNA
    s_sleep 1
    s_branch LW_CNA
LWX_CNA:
    s_mov_b32 s27, 0
    s_sleep 24
C_POLLN:
    buffer_load_dwordx4 v[112:115], v244, s[8:11], s18 offen offset:0 sc1
    buffer_load_dwordx4 v[116:119], v244, s[8:11], s18 offen offset:1024 sc1
    buffer_load_dwordx4 v[120:123], v244, s[8:11], s18 offen offset:2048 sc1
    buffer_load_dwordx4 v[124:127], v244, s[8:11], s18 offen offset:3072 sc1
    s_waitcnt vmcnt(0)
    v_xor_b32 v32, s36, v113
    v_xor_b32 v33, s36, v115
    v_xor_b32 v34, s36, v117
    v_xor_b32 v35, s36, v119
    v_xor_b32 v36, s36, v121
    v_xor_b32 v37, s36, v123
    v_xor_b32 v38, s36, v125
    v_xor_b32_e64 v39, s36, v127
    v_bitop3_b32 v254, v32, v33, v34 bitop3:0xfe
    v_bitop3_b32 v40, v35, v36, v37 bitop3:0xfe
    v_bitop3_b32 v254, v254, v38, v39 bitop3:0xfe
    v_or_b32 v254, v254, v40
    v_cmp_ne_u32 vcc, 0, v254
    s_add_u32 s27, s27, 1
    s_cmp_gt_u32 s27, 20000
    s_nop 2
    s_cbranch_scc1 C_POLLNX
    s_cbranch_vccz C_POLLNX
    s_sleep 8
    s_branch C_POLLN
C_POLLNX:
    buffer_load_dwordx4 v[96:99], v253, s[8:11], s24 offen offset:0 sc1
    buffer_load_dwordx4 v[100:103], v253, s[8:11], s24 offen offset:2048 sc1
    buffer_load_dwordx4 v[104:107], v253, s[8:11], s17 offen offset:0 sc1
    buffer_load_dwordx4 v[108:111], v253, s[8:11], s17 offen offset:2048 sc1
    s_lshl_b32 s16, s3, 13
    s_add_u32 s31, s16, 129536
    v_add_u32 v253, s31, v244
    v_and_b32 v113, 0xffff0000, v112
    v_lshlrev_b32 v112, 16, v112
    v_and_b32 v115, 0xffff0000, v114
    v_lshlrev_b32 v114, 16, v114
    v_and_b32 v117, 0xffff0000, v116
    v_lshlrev_b32 v116, 16, v116
    v_and_b32 v119, 0xffff0000, v118
    v_lshlrev_b32 v118, 16, v118
    v_and_b32 v121, 0xffff0000, v120
    v_lshlrev_b32 v120, 16, v120
    v_and_b32 v123, 0xffff0000, v122
    v_lshlrev_b32 v122, 16, v122
    v_and_b32 v125, 0xffff0000, v124
    v_lshlrev_b32 v124, 16, v124
    v_and_b32 v127, 0xffff0000, v126
    v_lshlrev_b32 v126, 16, v126
    ds_write_b128 v253, v[112:115] offset:4096
    ds_write_b128 v253, v[116:119] offset:5120
    ds_write_b128 v253, v[120:123] offset:6144
    ds_write_b128 v253, v[124:127] offset:7168
    s_waitcnt vmcnt(3)
    s_nop 0
    v_mfma_f32_32x32x16_f16 v[32:47], v[96:99], v[144:147], 0
    ds_write_b128 v253, v[96:99] offset:0
    v_fma_mix_f32 v0, v96, v112, 0 op_sel_hi:[1,0,0]
    v_fma_mix_f32 v1, v97, v113, 0 op_sel_hi:[1,0,0]
    v_fma_mix_f32 v2, v98, v114, 0 op_sel_hi:[1,0,0]
    v_fma_mix_f32 v3, v99, v115, 0 op_sel_hi:[1,0,0]
    v_mfma_f32_32x32x16_f16 v[48:63], v[96:99], v[160:163], 0
    v_fma_mix_f32 v16, -v96, v112, 0 op_sel:[1,0,0] op_sel_hi:[1,0,0]
    v_fma_mix_f32 v17, -v97, v113, 0 op_sel:[1,0,0] op_sel_hi:[1,0,0]
    v_fma_mix_f32 v18, -v98, v114, 0 op_sel:[1,0,0] op_sel_hi:[1,0,0]
    v_fma_mix_f32 v19, -v99, v115, 0 op_sel:[1,0,0] op_sel_hi:[1,0,0]
    s_waitcnt vmcnt(2)
    s_nop 0
    v_mfma_f32_32x32x16_f16 v[32:47], v[100:103], v[148:151], v[32:47]
    ds_write_b128 v253, v[100:103] offset:1024
    v_fma_mix_f32 v4, v100, v116, 0 op_sel_hi:[1,0,0]
    v_fma_mix_f32 v5, v101, v117, 0 op_sel_hi:[1,0,0]
    v_fma_mix_f32 v6, v102, v118, 0 op_sel_hi:[1,0,0]
    v_fma_mix_f32 v7, v103, v119, 0 op_sel_hi:[1,0,0]
    v_mfma_f32_32x32x16_f16 v[48:63], v[100:103], v[164:167], v[48:63]
    v_fma_mix_f32 v20, -v100, v116, 0 op_sel:[1,0,0] op_sel_hi:[1,0,0]
    v_fma_mix_f32 v21, -v101, v117, 0 op_sel:[1,0,0] op_sel_hi:[1,0,0]
    v_fma_mix_f32 v22, -v102, v118, 0 op_sel:[1,0,0] op_sel_hi:[1,0,0]
    v_fma_mix_f32 v23, -v103, v119, 0 op_sel:[1,0,0] op_sel_hi:[1,0,0]
    s_waitcnt vmcnt(1)
    s_nop 0
    v_mfma_f32_32x32x16_f16 v[32:47], v[104:107], v[152:155], v[32:47]
    ds_write_b128 v253, v[104:107] offset:2048
    v_fma_mix_f32 v8, v104, v120, 0 op_sel_hi:[1,0,0]
    v_fma_mix_f32 v9, v105, v121, 0 op_sel_hi:[1,0,0]
    v_fma_mix_f32 v10, v106, v122, 0 op_sel_hi:[1,0,0]
    v_fma_mix_f32 v11, v107, v123, 0 op_sel_hi:[1,0,0]
    v_mfma_f32_32x32x16_f16 v[48:63], v[104:107], v[168:171], v[48:63]
    v_fma_mix_f32 v24, -v104, v120, 0 op_sel:[1,0,0] op_sel_hi:[1,0,0]
    v_fma_mix_f32 v25, -v105, v121, 0 op_sel:[1,0,0] op_sel_hi:[1,0,0]
    v_fma_mix_f32 v26, -v106, v122, 0 op_sel:[1,0,0] op_sel_hi:[1,0,0]
    v_fma_mix_f32 v27, -v107, v123, 0 op_sel:[1,0,0] op_sel_hi:[1,0,0]
    s_waitcnt vmcnt(0)
    s_nop 0
    v_mfma_f32_32x32x16_f16 v[32:47], v[108:111], v[156:159], v[32:47]
    ds_write_b128 v253, v[108:111] offset:3072
    v_fma_mix_f32 v12, v108, v124, 0 op_sel_hi:[1,0,0]
    v_fma_mix_f32 v13, v109, v125, 0 op_sel_hi:[1,0,0]
    v_fma_mix_f32 v14, v110, v126, 0 op_sel_hi:[1,0,0]
    v_fma_mix_f32 v15, v111, v127, 0 op_sel_hi:[1,0,0]
    v_mfma_f32_32x32x16_f16 v[48:63], v[108:111], v[172:175], v[48:63]
    v_fma_mix_f32 v28, -v108, v124, 0 op_sel:[1,0,0] op_sel_hi:[1,0,0]
    v_fma_mix_f32 v29, -v109, v125, 0 op_sel:[1,0,0] op_sel_hi:[1,0,0]
    v_fma_mix_f32 v30, -v110, v126, 0 op_sel:[1,0,0] op_sel_hi:[1,0,0]
    v_fma_mix_f32 v31, -v111, v127, 0 op_sel:[1,0,0] op_sel_hi:[1,0,0]
    s_waitcnt lgkmcnt(0)
    s_nop 6
    v_cvt_pk_f16_f32 v112, v32, v48
    v_cvt_pk_f16_f32 v113, v33, v49
    v_cvt_pk_f16_f32 v114, v34, v50
    v_cvt_pk_f16_f32 v115, v35, v51
    v_pk_mul_f16 v96, v112, v128 op_sel:[0,0] op_sel_hi:[1,0]
    v_pk_mul_f16 v97, v113, v129 op_sel:[0,0] op_sel_hi:[1,0]
    v_pk_mul_f16 v98, v114, v130 op_sel:[0,0] op_sel_hi:[1,0]
    v_pk_mul_f16 v99, v115, v131 op_sel:[0,0] op_sel_hi:[1,0]
    v_pk_fma_f16 v96, v112, v128, v96 op_sel:[1,1,0] op_sel_hi:[0,1,1] neg_lo:[1,0,0]
    v_pk_fma_f16 v97, v113, v129, v97 op_sel:[1,1,0] op_sel_hi:[0,1,1] neg_lo:[1,0,0]
    v_pk_fma_f16 v98, v114, v130, v98 op_sel:[1,1,0] op_sel_hi:[0,1,1] neg_lo:[1,0,0]
    v_pk_fma_f16 v99, v115, v131, v99 op_sel:[1,1,0] op_sel_hi:[0,1,1] neg_lo:[1,0,0]
    v_cvt_pk_f16_f32 v116, v36, v52
    v_cvt_pk_f16_f32 v117, v37, v53
    v_mfma_f32_32x32x16_f16 v[64:79], v[144:147], v[96:99], 0
    v_cvt_pk_f16_f32 v118, v38, v54
    v_cvt_pk_f16_f32 v119, v39, v55
    v_pk_mul_f16 v100, v116, v132 op_sel:[0,0] op_sel_hi:[1,0]
    v_pk_mul_f16 v101, v117, v133 op_sel:[0,0] op_sel_hi:[1,0]
    v_pk_mul_f16 v102, v118, v134 op_sel:[0,0] op_sel_hi:[1,0]
    v_pk_mul_f16 v103, v119, v135 op_sel:[0,0] op_sel_hi:[1,0]
    v_mfma_f32_32x32x16_f16 v[80:95], v[160:163], v[96:99], 0
    v_pk_fma_f16 v100, v116, v132, v100 op_sel:[1,1,0] op_sel_hi:[0,1,1] neg_lo:[1,0,0]
    v_pk_fma_f16 v101, v117, v133, v101 op_sel:[1,1,0] op_sel_hi:[0,1,1] neg_lo:[1,0,0]
    v_pk_fma_f16 v102, v118, v134, v102 op_sel:[1,1,0] op_sel_hi:[0,1,1] neg_lo:[1,0,0]
    v_pk_fma_f16 v103, v119, v135, v103 op_sel:[1,1,0] op_sel_hi:[0,1,1] neg_lo:[1,0,0]
    v_cvt_pk_f16_f32 v120, v40, v56
    v_cvt_pk_f16_f32 v121, v41, v57
    v_mfma_f32_32x32x16_f16 v[64:79], v[148:151], v[100:103], v[64:79]
    v_cvt_pk_f16_f32 v122, v42, v58
    v_cvt_pk_f16_f32 v123, v43, v59
    v_pk_mul_f16 v104, v120, v136 op_sel:[0,0] op_sel_hi:[1,0]
    v_pk_mul_f16 v105, v121, v137 op_sel:[0,0] op_sel_hi:[1,0]
    v_pk_mul_f16 v106, v122, v138 op_sel:[0,0] op_sel_hi:[1,0]
    v_pk_mul_f16 v107, v123, v139 op_sel:[0,0] op_sel_hi:[1,0]
    v_mfma_f32_32x32x16_f16 v[80:95], v[164:167], v[100:103], v[80:95]
    v_pk_fma_f16 v104, v120, v136, v104 op_sel:[1,1,0] op_sel_hi:[0,1,1] neg_lo:[1,0,0]
    v_pk_fma_f16 v105, v121, v137, v105 op_sel:[1,1,0] op_sel_hi:[0,1,1] neg_lo:[1,0,0]
    v_pk_fma_f16 v106, v122, v138, v106 op_sel:[1,1,0] op_sel_hi:[0,1,1] neg_lo:[1,0,0]
    v_pk_fma_f16 v107, v123, v139, v107 op_sel:[1,1,0] op_sel_hi:[0,1,1] neg_lo:[1,0,0]
    v_cvt_pk_f16_f32 v124, v44, v60
    v_cvt_pk_f16_f32 v125, v45, v61
    v_mfma_f32_32x32x16_f16 v[64:79], v[152:155], v[104:107], v[64:79]
    v_cvt_pk_f16_f32 v126, v46, v62
    v_cvt_pk_f16_f32 v127, v47, v63
    v_pk_mul_f16 v108, v124, v140 op_sel:[0,0] op_sel_hi:[1,0]
    v_pk_mul_f16 v109, v125, v141 op_sel:[0,0] op_sel_hi:[1,0]
    v_pk_mul_f16 v110, v126, v142 op_sel:[0,0] op_sel_hi:[1,0]
    v_pk_mul_f16 v111, v127, v143 op_sel:[0,0] op_sel_hi:[1,0]
    v_mfma_f32_32x32x16_f16 v[80:95], v[168:171], v[104:107], v[80:95]
    v_pk_fma_f16 v108, v124, v140, v108 op_sel:[1,1,0] op_sel_hi:[0,1,1] neg_lo:[1,0,0]
    v_pk_fma_f16 v109, v125, v141, v109 op_sel:[1,1,0] op_sel_hi:[0,1,1] neg_lo:[1,0,0]
    v_pk_fma_f16 v110, v126, v142, v110 op_sel:[1,1,0] op_sel_hi:[0,1,1] neg_lo:[1,0,0]
    v_pk_fma_f16 v111, v127, v143, v111 op_sel:[1,1,0] op_sel_hi:[0,1,1] neg_lo:[1,0,0]
    s_nop 1
    v_mfma_f32_32x32x16_f16 v[64:79], v[156:159], v[108:111], v[64:79]
    v_mfma_f32_32x32x16_f16 v[80:95], v[172:175], v[108:111], v[80:95]
    v_mov_b32 v253, s28
    v_mov_b32 v254, 1
    s_nop 9
    v_cvt_pk_f16_f32 v96, v64, v80
    v_cvt_pk_f16_f32 v97, v65, v81
    v_cvt_pk_f16_f32 v98, v66, v82
    v_cvt_pk_f16_f32 v99, v67, v83
    ds_write_b128 v245, v[96:99] offset:0
    v_cvt_pk_f16_f32 v100, v68, v84
    v_cvt_pk_f16_f32 v101, v69, v85
    v_cvt_pk_f16_f32 v102, v70, v86
    v_cvt_pk_f16_f32 v103, v71, v87
    ds_write_b128 v245, v[100:103] offset:1024
    v_cvt_pk_f16_f32 v104, v72, v88
    v_cvt_pk_f16_f32 v105, v73, v89
    v_cvt_pk_f16_f32 v106, v74, v90
    v_cvt_pk_f16_f32 v107, v75, v91
    ds_write_b128 v245, v[104:107] offset:2048
    v_cvt_pk_f16_f32 v108, v76, v92
    v_cvt_pk_f16_f32 v109, v77, v93
    v_cvt_pk_f16_f32 v110, v78, v94
    v_cvt_pk_f16_f32 v111, v79, v95
    ds_write_b128 v245, v[108:111] offset:3072
    ds_write_b32 v253, v254 offset:24608
    s_add_u32 s16, s46, 80256
    v_add_u32 v32, s16, v244
    s_add_u32 s16, s47, 80256
    v_add_u32 v33, s16, v244
    s_mov_b32 s27, 0
    s_nop 0
LW_PQ0:
    ds_read_b32 v254, v255 offset:24588
    s_add_u32 s27, s27, 1
    s_waitcnt lgkmcnt(0)
    v_readfirstlane_b32 s16, v254
    s_cmp_gt_u32 s27, 0xc3500
    s_nop 3
    s_cbranch_scc1 LWX_PQ0
    s_cmp_ge_u32 s16, 4
    s_cbranch_scc1 LWX_PQ0
    s_sleep 1
    s_branch LW_PQ0
LWX_PQ0:
    s_nop 0
    ds_read_b32 v34, v255 offset:24580
    ds_read_b128 v[176:179], v32 offset:0
    ds_read_b128 v[180:183], v32 offset:1024
    ds_read_b128 v[184:187], v32 offset:2048
    ds_read_b128 v[188:191], v32 offset:3072
    ds_read_b128 v[192:195], v33 offset:0
    ds_read_b128 v[196:199], v33 offset:1024
    ds_read_b128 v[200:203], v33 offset:2048
    ds_read_b128 v[204:207], v33 offset:3072
    s_waitcnt lgkmcnt(8)
    v_readfirstlane_b32 s33, v34
    s_nop 0
    s_sub_u32 s25, 250, s33
    s_lshl_b32 s25, s25, 23
    s_waitcnt lgkmcnt(4)
    s_nop 0
    v_pk_mul_f16 v64, v96, v176 op_sel:[0,0] op_sel_hi:[1,0] neg_hi:[1,0]
    v_pk_mul_f16 v65, v97, v177 op_sel:[0,0] op_sel_hi:[1,0] neg_hi:[1,0]
    v_pk_mul_f16 v66, v98, v178 op_sel:[0,0] op_sel_hi:[1,0] neg_hi:[1,0]
    v_pk_mul_f16 v67, v99, v179 op_sel:[0,0] op_sel_hi:[1,0] neg_hi:[1,0]
    v_pk_mul_f16 v68, v100, v180 op_sel:[0,0] op_sel_hi:[1,0] neg_hi:[1,0]
    v_pk_mul_f16 v69, v101, v181 op_sel:[0,0] op_sel_hi:[1,0] neg_hi:[1,0]
    v_pk_mul_f16 v70, v102, v182 op_sel:[0,0] op_sel_hi:[1,0] neg_hi:[1,0]
    v_pk_mul_f16 v71, v103, v183 op_sel:[0,0] op_sel_hi:[1,0] neg_hi:[1,0]
    v_mov_b32_e64 v253, s29
    ds_read_b32 v254, v253 offset:24608
    ds_read_b128 v[112:115], v247 offset:0
    ds_read_b128 v[116:119], v247 offset:1024
    ds_read_b128 v[120:123], v247 offset:2048
    ds_read_b128 v[124:127], v247 offset:3072
    v_pk_mul_f16 v72, v104, v184 op_sel:[0,0] op_sel_hi:[1,0] neg_hi:[1,0]
    v_pk_mul_f16 v73, v105, v185 op_sel:[0,0] op_sel_hi:[1,0] neg_hi:[1,0]
    v_pk_mul_f16 v74, v106, v186 op_sel:[0,0] op_sel_hi:[1,0] neg_hi:[1,0]
    v_pk_mul_f16 v75, v107, v187 op_sel:[0,0] op_sel_hi:[1,0] neg_hi:[1,0]
    v_pk_mul_f16 v76, v108, v188 op_sel:[0,0] op_sel_hi:[1,0] neg_hi:[1,0]
    v_pk_mul_f16 v77, v109, v189 op_sel:[0,0] op_sel_hi:[1,0] neg_hi:[1,0]
    v_pk_mul_f16 v78, v110, v190 op_sel:[0,0] op_sel_hi:[1,0] neg_hi:[1,0]
    v_pk_mul_f16 v79, v111, v191 op_sel:[0,0] op_sel_hi:[1,0] neg_hi:[1,0]
    v_pk_fma_f16 v64, v96, v176, v64 op_sel:[1,1,0] op_sel_hi:[0,1,1] neg_lo:[1,0,0] neg_hi:[1,0,0]
    v_pk_fma_f16 v65, v97, v177, v65 op_sel:[1,1,0] op_sel_hi:[0,1,1] neg_lo:[1,0,0] neg_hi:[1,0,0]
    v_pk_fma_f16 v66, v98, v178, v66 op_sel:[1,1,0] op_sel_hi:[0,1,1] neg_lo:[1,0,0] neg_hi:[1,0,0]
    v_pk_fma_f16 v67, v99, v179, v67 op_sel:[1,1,0] op_sel_hi:[0,1,1] neg_lo:[1,0,0] neg_hi:[1,0,0]
    v_pk_fma_f16 v68, v100, v180, v68 op_sel:[1,1,0] op_sel_hi:[0,1,1] neg_lo:[1,0,0] neg_hi:[1,0,0]
    v_pk_fma_f16 v69, v101, v181, v69 op_sel:[1,1,0] op_sel_hi:[0,1,1] neg_lo:[1,0,0] neg_hi:[1,0,0]
    v_pk_fma_f16 v70, v102, v182, v70 op_sel:[1,1,0] op_sel_hi:[0,1,1] neg_lo:[1,0,0] neg_hi:[1,0,0]
    v_pk_fma_f16 v71, v103, v183, v71 op_sel:[1,1,0] op_sel_hi:[0,1,1] neg_lo:[1,0,0] neg_hi:[1,0,0]
    v_pk_fma_f16 v72, v104, v184, v72 op_sel:[1,1,0] op_sel_hi:[0,1,1] neg_lo:[1,0,0] neg_hi:[1,0,0]
    v_pk_fma_f16 v73, v105, v185, v73 op_sel:[1,1,0] op_sel_hi:[0,1,1] neg_lo:[1,0,0] neg_hi:[1,0,0]
    v_pk_fma_f16 v74, v106, v186, v74 op_sel:[1,1,0] op_sel_hi:[0,1,1] neg_lo:[1,0,0] neg_hi:[1,0,0]
    v_pk_fma_f16 v75, v107, v187, v75 op_sel:[1,1,0] op_sel_hi:[0,1,1] neg_lo:[1,0,0] neg_hi:[1,0,0]
    v_pk_fma_f16 v76, v108, v188, v76 op_sel:[1,1,0] op_sel_hi:[0,1,1] neg_lo:[1,0,0] neg_hi:[1,0,0]
    v_pk_fma_f16 v77, v109, v189, v77 op_sel:[1,1,0] op_sel_hi:[0,1,1] neg_lo:[1,0,0] neg_hi:[1,0,0]
    v_pk_fma_f16 v78, v110, v190, v78 op_sel:[1,1,0] op_sel_hi:[0,1,1] neg_lo:[1,0,0] neg_hi:[1,0,0]
    v_pk_fma_f16 v79, v111, v191, v79 op_sel:[1,1,0] op_sel_hi:[0,1,1] neg_lo:[1,0,0] neg_hi:[1,0,0]
    v_mul_f32 v0, s25, v0
    v_mul_f32 v1, s25, v1
    v_mul_f32 v2, s25, v2
    v_mul_f32 v3, s25, v3
    v_mul_f32 v4, s25, v4
    v_mul_f32 v5, s25, v5
    v_mul_f32 v6, s25, v6
    v_mul_f32 v7, s25, v7
    s_waitcnt lgkmcnt(4)
    v_readfirstlane_b32 s16, v254
    s_nop 0
    s_cmp_ge_u32 s16, 1
    s_nop 2
    s_cbranch_scc1 C_XOK_0
    s_mov_b32 s27, 0
LS_X0:
    s_nop 0
    ds_read_b32 v254, v253 offset:24608
    ds_read_b128 v[112:115], v247 offset:0
    ds_read_b128 v[116:119], v247 offset:1024
    ds_read_b128 v[120:123], v247 offset:2048
    ds_read_b128 v[124:127], v247 offset:3072
    s_add_u32 s27, s27, 1
    s_waitcnt lgkmcnt(4)
    v_readfirstlane_b32 s16, v254
    s_cmp_gt_u32 s27, 0xc3500
    s_nop 3
    s_cbranch_scc1 LSX_X0
    s_cmp_ge_u32 s16, 1
    s_cbranch_scc0 LS_X0
LSX_X0:
C_XOK_0:
    s_waitcnt lgkmcnt(3)
    v_pk_fma_f16 v64, v112, v192, v64 op_sel:[0,0,0] op_sel_hi:[1,0,1] neg_hi:[1,0,0]
    v_pk_fma_f16 v65, v113, v193, v65 op_sel:[0,0,0] op_sel_hi:[1,0,1] neg_hi:[1,0,0]
    v_pk_fma_f16 v66, v114, v194, v66 op_sel:[0,0,0] op_sel_hi:[1,0,1] neg_hi:[1,0,0]
    v_pk_fma_f16 v67, v115, v195, v67 op_sel:[0,0,0] op_sel_hi:[1,0,1] neg_hi:[1,0,0]
    v_pk_fma_f16 v64, v112, v192, v64 op_sel:[1,1,0] op_sel_hi:[0,1,1] neg_lo:[1,0,0] neg_hi:[1,0,0]
    v_pk_fma_f16 v65, v113, v193, v65 op_sel:[1,1,0] op_sel_hi:[0,1,1] neg_lo:[1,0,0] neg_hi:[1,0,0]
    v_pk_fma_f16 v66, v114, v194, v66 op_sel:[1,1,0] op_sel_hi:[0,1,1] neg_lo:[1,0,0] neg_hi:[1,0,0]
    v_pk_fma_f16 v67, v115, v195, v67 op_sel:[1,1,0] op_sel_hi:[0,1,1] neg_lo:[1,0,0] neg_hi:[1,0,0]
    s_waitcnt lgkmcnt(2)
    s_nop 0
    v_pk_fma_f16 v68, v116, v196, v68 op_sel:[0,0,0] op_sel_hi:[1,0,1] neg_hi:[1,0,0]
    v_mfma_f32_32x32x16_f16 v[32:47], v[64:67], v[144:147], 0
    v_pk_fma_f16 v69, v117, v197, v69 op_sel:[0,0,0] op_sel_hi:[1,0,1] neg_hi:[1,0,0]
    v_pk_fma_f16 v70, v118, v198, v70 op_sel:[0,0,0] op_sel_hi:[1,0,1] neg_hi:[1,0,0]
    v_pk_fma_f16 v71, v119, v199, v71 op_sel:[0,0,0] op_sel_hi:[1,0,1] neg_hi:[1,0,0]
    v_pk_fma_f16 v68, v116, v196, v68 op_sel:[1,1,0] op_sel_hi:[0,1,1] neg_lo:[1,0,0] neg_hi:[1,0,0]
    v_pk_fma_f16 v69, v117, v197, v69 op_sel:[1,1,0] op_sel_hi:[0,1,1] neg_lo:[1,0,0] neg_hi:[1,0,0]
    v_pk_fma_f16 v70, v118, v198, v70 op_sel:[1,1,0] op_sel_hi:[0,1,1] neg_lo:[1,0,0] neg_hi:[1,0,0]
    v_mfma_f32_32x32x16_f16 v[48:63], v[64:67], v[160:163], 0
    v_pk_fma_f16 v71, v119, v199, v71 op_sel:[1,1,0] op_sel_hi:[0,1,1] neg_lo:[1,0,0] neg_hi:[1,0,0]
    s_waitcnt lgkmcnt(1)
    s_nop 0
    v_pk_fma_f16 v72, v120, v200, v72 op_sel:[0,0,0] op_sel_hi:[1,0,1] neg_hi:[1,0,0]
    v_pk_fma_f16 v73, v121, v201, v73 op_sel:[0,0,0] op_sel_hi:[1,0,1] neg_hi:[1,0,0]
    v_pk_fma_f16 v74, v122, v202, v74 op_sel:[0,0,0] op_sel_hi:[1,0,1] neg_hi:[1,0,0]
    v_pk_fma_f16 v75, v123, v203, v75 op_sel:[0,0,0] op_sel_hi:[1,0,1] neg_hi:[1,0,0]
    v_mfma_f32_32x32x16_f16 v[32:47], v[68:71], v[148:151], v[32:47]
    v_pk_fma_f16 v72, v120, v200, v72 op_sel:[1,1,0] op_sel_hi:[0,1,1] neg_lo:[1,0,0] neg_hi:[1,0,0]
    v_pk_fma_f16 v73, v121, v201, v73 op_sel:[1,1,0] op_sel_hi:[0,1,1] neg_lo:[1,0,0] neg_hi:[1,0,0]
    v_pk_fma_f16 v74, v122, v202, v74 op_sel:[1,1,0] op_sel_hi:[0,1,1] neg_lo:[1,0,0] neg_hi:[1,0,0]
    v_pk_fma_f16 v75, v123, v203, v75 op_sel:[1,1,0] op_sel_hi:[0,1,1] neg_lo:[1,0,0] neg_hi:[1,0,0]
    s_waitcnt lgkmcnt(0)
    s_nop 0
    v_pk_fma_f16 v76, v124, v204, v76 op_sel:[0,0,0] op_sel_hi:[1,0,1] neg_hi:[1,0,0]
    v_mfma_f32_32x32x16_f16 v[48:63], v[68:71], v[164:167], v[48:63]
    v_pk_fma_f16 v77, v125, v205, v77 op_sel:[0,0,0] op_sel_hi:[1,0,1] neg_hi:[1,0,0]
    v_pk_fma_f16 v78, v126, v206, v78 op_sel:[0,0,0] op_sel_hi:[1,0,1] neg_hi:[1,0,0]
    v_pk_fma_f16 v79, v127, v207, v79 op_sel:[0,0,0] op_sel_hi:[1,0,1] neg_hi:[1,0,0]
    v_pk_fma_f16 v76, v124, v204, v76 op_sel:[1,1,0] op_sel_hi:[0,1,1] neg_lo:[1,0,0] neg_hi:[1,0,0]
    v_pk_fma_f16 v77, v125, v205, v77 op_sel:[1,1,0] op_sel_hi:[0,1,1] neg_lo:[1,0,0] neg_hi:[1,0,0]
    v_pk_fma_f16 v78, v126, v206, v78 op_sel:[1,1,0] op_sel_hi:[0,1,1] neg_lo:[1,0,0] neg_hi:[1,0,0]
    v_mfma_f32_32x32x16_f16 v[32:47], v[72:75], v[152:155], v[32:47]
    v_pk_fma_f16 v79, v127, v207, v79 op_sel:[1,1,0] op_sel_hi:[0,1,1] neg_lo:[1,0,0] neg_hi:[1,0,0]
    v_mul_f32 v8, s25, v8
    v_mul_f32 v9, s25, v9
    v_mul_f32 v10, s25, v10
    v_mul_f32 v11, s25, v11
    v_mul_f32 v12, s25, v12
    v_mfma_f32_32x32x16_f16 v[48:63], v[72:75], v[168:171], v[48:63]
    v_mul_f32 v13, s25, v13
    v_mul_f32 v14, s25, v14
    v_mul_f32 v15, s25, v15
    v_mul_f32 v16, s25, v16
    v_mul_f32 v17, s25, v17
    v_mul_f32 v18, s25, v18
    v_mfma_f32_32x32x16_f16 v[32:47], v[76:79], v[156:159], v[32:47]
    v_mul_f32 v19, s25, v19
    v_mul_f32 v20, s25, v20
    v_mul_f32 v21, s25, v21
    v_mul_f32 v22, s25, v22
    v_mul_f32 v23, s25, v23
    v_mul_f32 v24, s25, v24
    v_mfma_f32_32x32x16_f16 v[48:63], v[76:79], v[172:175], v[48:63]
    v_mul_f32 v25, s25, v25
    v_mul_f32 v26, s25, v26
    v_mul_f32 v27, s25, v27
    v_mul_f32 v28, s25, v28
    v_mul_f32 v29, s25, v29
    v_mul_f32 v30, s25, v30
    v_mul_f32 v31, s25, v31
    s_nop 4
    s_nop 0
    v_cvt_pk_f16_f32 v112, v32, v48
    v_cvt_pk_f16_f32 v113, v33, v49
    v_cvt_pk_f16_f32 v114, v34, v50
    v_cvt_pk_f16_f32 v115, v35, v51
    v_pk_mul_f16 v96, v112, v128 op_sel:[0,0] op_sel_hi:[1,0]
    v_pk_mul_f16 v97, v113, v129 op_sel:[0,0] op_sel_hi:[1,0]
    v_pk_mul_f16 v98, v114, v130 op_sel:[0,0] op_sel_hi:[1,0]
    v_pk_mul_f16 v99, v115, v131 op_sel:[0,0] op_sel_hi:[1,0]
    v_pk_fma_f16 v96, v112, v128, v96 op_sel:[1,1,0] op_sel_hi:[0,1,1] neg_lo:[1,0,0]
    v_pk_fma_f16 v97, v113, v129, v97 op_sel:[1,1,0] op_sel_hi:[0,1,1] neg_lo:[1,0,0]
    v_pk_fma_f16 v98, v114, v130, v98 op_sel:[1,1,0] op_sel_hi:[0,1,1] neg_lo:[1,0,0]
    v_pk_fma_f16 v99, v115, v131, v99 op_sel:[1,1,0] op_sel_hi:[0,1,1] neg_lo:[1,0,0]
    v_cvt_pk_f16_f32 v116, v36, v52
    v_cvt_pk_f16_f32 v117, v37, v53
    v_mfma_f32_32x32x16_f16 v[0:15], v[144:147], v[96:99], v[0:15]
    v_cvt_pk_f16_f32 v118, v38, v54
    v_cvt_pk_f16_f32 v119, v39, v55
    v_pk_mul_f16 v100, v116, v132 op_sel:[0,0] op_sel_hi:[1,0]
    v_pk_mul_f16 v101, v117, v133 op_sel:[0,0] op_sel_hi:[1,0]
    v_pk_mul_f16 v102, v118, v134 op_sel:[0,0] op_sel_hi:[1,0]
    v_pk_mul_f16 v103, v119, v135 op_sel:[0,0] op_sel_hi:[1,0]
    v_mfma_f32_32x32x16_f16 v[16:31], v[160:163], v[96:99], v[16:31]
    v_pk_fma_f16 v100, v116, v132, v100 op_sel:[1,1,0] op_sel_hi:[0,1,1] neg_lo:[1,0,0]
    v_pk_fma_f16 v101, v117, v133, v101 op_sel:[1,1,0] op_sel_hi:[0,1,1] neg_lo:[1,0,0]
    v_pk_fma_f16 v102, v118, v134, v102 op_sel:[1,1,0] op_sel_hi:[0,1,1] neg_lo:[1,0,0]
    v_pk_fma_f16 v103, v119, v135, v103 op_sel:[1,1,0] op_sel_hi:[0,1,1] neg_lo:[1,0,0]
    v_cvt_pk_f16_f32 v120, v40, v56
    v_cvt_pk_f16_f32 v121, v41, v57
    v_mfma_f32_32x32x16_f16 v[0:15], v[148:151], v[100:103], v[0:15]
    v_cvt_pk_f16_f32 v122, v42, v58
    v_cvt_pk_f16_f32 v123, v43, v59
    v_pk_mul_f16 v104, v120, v136 op_sel:[0,0] op_sel_hi:[1,0]
    v_pk_mul_f16 v105, v121, v137 op_sel:[0,0] op_sel_hi:[1,0]
    v_pk_mul_f16 v106, v122, v138 op_sel:[0,0] op_sel_hi:[1,0]
    v_pk_mul_f16 v107, v123, v139 op_sel:[0,0] op_sel_hi:[1,0]
    v_mfma_f32_32x32x16_f16 v[16:31], v[164:167], v[100:103], v[16:31]
    v_pk_fma_f16 v104, v120, v136, v104 op_sel:[1,1,0] op_sel_hi:[0,1,1] neg_lo:[1,0,0]
    v_pk_fma_f16 v105, v121, v137, v105 op_sel:[1,1,0] op_sel_hi:[0,1,1] neg_lo:[1,0,0]
    v_pk_fma_f16 v106, v122, v138, v106 op_sel:[1,1,0] op_sel_hi:[0,1,1] neg_lo:[1,0,0]
    v_pk_fma_f16 v107, v123, v139, v107 op_sel:[1,1,0] op_sel_hi:[0,1,1] neg_lo:[1,0,0]
    v_cvt_pk_f16_f32 v124, v44, v60
    v_cvt_pk_f16_f32 v125, v45, v61
    v_mfma_f32_32x32x16_f16 v[0:15], v[152:155], v[104:107], v[0:15]
    v_cvt_pk_f16_f32 v126, v46, v62
    v_cvt_pk_f16_f32 v127, v47, v63
    v_pk_mul_f16 v108, v124, v140 op_sel:[0,0] op_sel_hi:[1,0]
    v_pk_mul_f16 v109, v125, v141 op_sel:[0,0] op_sel_hi:[1,0]
    v_pk_mul_f16 v110, v126, v142 op_sel:[0,0] op_sel_hi:[1,0]
    v_pk_mul_f16 v111, v127, v143 op_sel:[0,0] op_sel_hi:[1,0]
    v_mfma_f32_32x32x16_f16 v[16:31], v[168:171], v[104:107], v[16:31]
    v_pk_fma_f16 v108, v124, v140, v108 op_sel:[1,1,0] op_sel_hi:[0,1,1] neg_lo:[1,0,0]
    v_pk_fma_f16 v109, v125, v141, v109 op_sel:[1,1,0] op_sel_hi:[0,1,1] neg_lo:[1,0,0]
    v_pk_fma_f16 v110, v126, v142, v110 op_sel:[1,1,0] op_sel_hi:[0,1,1] neg_lo:[1,0,0]
    v_pk_fma_f16 v111, v127, v143, v111 op_sel:[1,1,0] op_sel_hi:[0,1,1] neg_lo:[1,0,0]
    s_nop 1
    v_mfma_f32_32x32x16_f16 v[0:15], v[156:159], v[108:111], v[0:15]
    v_mfma_f32_32x32x16_f16 v[16:31], v[172:175], v[108:111], v[16:31]
    v_mov_b32 v253, s28
    v_mov_b32 v254, 1
    v_mov_b32 v80, s30
    v_mov_b32 v82, 1
    s_cmp_lg_u32 s14, 387
    s_nop 6
    s_cbranch_scc1 CC_REG_0
    v_mov_b32 v16, 0
    v_mov_b32 v17, 0
    v_mov_b32 v18, 0
    v_mov_b32 v19, 0
    v_mov_b32 v20, 0
    v_mov_b32 v21, 0
    v_mov_b32 v22, 0
    v_mov_b32 v23, 0
    v_mov_b32 v24, 0
    v_mov_b32 v25, 0
    v_mov_b32 v26, 0
    v_mov_b32 v27, 0
    v_mov_b32 v28, 0
    v_mov_b32 v29, 0
    v_mov_b32 v30, 0
    v_mov_b32_e64 v31, 0
    v_mul_f32 v48, 0x3f3504f3, v0
    v_mul_f32 v49, 0x3f3504f3, v1
    v_mul_f32 v50, 0x3f3504f3, v2
    v_mul_f32 v51, 0x3f3504f3, v3
    v_mul_f32 v52, 0x3f3504f3, v4
    v_mul_f32 v53, 0x3f3504f3, v5
    v_mul_f32 v54, 0x3f3504f3, v6
    v_mul_f32 v55, 0x3f3504f3, v7
    v_mul_f32 v56, 0x3f3504f3, v8
    v_mul_f32 v57, 0x3f3504f3, v9
    v_mul_f32 v58, 0x3f3504f3, v10
    v_mul_f32 v59, 0x3f3504f3, v11
    v_mul_f32 v60, 0x3f3504f3, v12
    v_mul_f32 v61, 0x3f3504f3, v13
    v_mul_f32 v62, 0x3f3504f3, v14
    v_mul_f32 v63, 0x3f3504f3, v15
    v_mul_f32 v32, v48, v48
    v_mul_f32 v33, v49, v49
    v_mul_f32 v34, v50, v50
    v_mul_f32 v35, v51, v51
    v_mul_f32 v36, v52, v52
    v_mul_f32 v37, v53, v53
    v_mul_f32 v38, v54, v54
    v_mul_f32 v39, v55, v55
    v_mul_f32 v40, v56, v56
    v_mul_f32 v41, v57, v57
    v_mul_f32 v42, v58, v58
    v_mul_f32 v43, v59, v59
    v_mul_f32 v44, v60, v60
    v_mul_f32 v45, v61, v61
    v_mul_f32 v46, v62, v62
    v_mul_f32 v47, v63, v63
    s_cmp_eq_u32 s13, 0
    s_nop 0
    s_cbranch_scc1 CC_S0_0
    s_branch CC_S1_0
CC_REG_0:
    s_cmp_eq_u32 s13, 0
    s_cbranch_scc0 CC_E1_0
    v_mul_f32 v40, v8, v8
    v_mul_f32 v41, v9, v9
    v_mul_f32 v42, v10, v10
    v_mul_f32 v43, v11, v11
    v_mul_f32 v44, v12, v12
    v_mul_f32 v45, v13, v13
    v_mul_f32 v46, v14, v14
    v_mul_f32 v47, v15, v15
    v_fmac_f32 v40, v24, v24
    v_fmac_f32 v41, v25, v25
    v_fmac_f32 v42, v26, v26
    v_fmac_f32 v43, v27, v27
    v_fmac_f32 v44, v28, v28
    v_fmac_f32 v45, v29, v29
    v_fmac_f32 v46, v30, v30
    v_fmac_f32 v47, v31, v31
    ds_write_b128 v248, v[40:43]
    ds_write_b128 v248, v[44:47] offset:1024
    ds_write_b32 v253, v254 offset:24624
    v_mul_f32 v32, v0, v0
    v_mul_f32 v33, v1, v1
    v_mul_f32 v34, v2, v2
    v_mul_f32 v35, v3, v3
    v_mul_f32 v36, v4, v4
    v_mul_f32 v37, v5, v5
    v_mul_f32 v38, v6, v6
    v_mul_f32 v39, v7, v7
    v_fmac_f32 v32, v16, v16
    v_fmac_f32 v33, v17, v17
    v_fmac_f32 v34, v18, v18
    v_fmac_f32 v35, v19, v19
    v_fmac_f32 v36, v20, v20
    v_fmac_f32 v37, v21, v21
    v_fmac_f32 v38, v22, v22
    v_fmac_f32 v39, v23, v23
    s_nop 1
    s_branch CC_R0_0
CC_S0_0:
    ds_write_b128 v248, v[40:43]
    ds_write_b128 v248, v[44:47] offset:1024
    ds_write_b32 v253, v254 offset:24624
CC_R0_0:
    s_mov_b32 s27, 0
LS_EN0_0:
    s_nop 0
    ds_read_b32 v81, v80 offset:24624
    ds_read_b128 v[48:51], v249
    ds_read_b128 v[52:55], v249 offset:1024
    s_add_u32 s27, s27, 1
    s_waitcnt lgkmcnt(2)
    v_readfirstlane_b32 s16, v81
    s_cmp_gt_u32 s27, 0xc3500
    s_nop 3
    s_cbranch_scc1 LSX_EN0_0
    s_cmp_ge_u32 s16, 1
    s_cbranch_scc0 LS_EN0_0
LSX_EN0_0:
    s_waitcnt lgkmcnt(0)
    v_add_f32 v48, v48, v32
    v_add_f32 v49, v49, v33
    v_add_f32 v50, v50, v34
    v_add_f32 v51, v51, v35
    v_add_f32 v52, v52, v36
    v_add_f32 v53, v53, v37
    v_add_f32 v54, v54, v38
    v_add_f32 v55, v55, v39
    s_nop 1
    s_branch CC_E2_0
CC_E1_0:
    v_mul_f32 v32, v0, v0
    v_mul_f32 v33, v1, v1
    v_mul_f32 v34, v2, v2
    v_mul_f32 v35, v3, v3
    v_mul_f32 v36, v4, v4
    v_mul_f32 v37, v5, v5
    v_mul_f32 v38, v6, v6
    v_mul_f32 v39, v7, v7
    v_fmac_f32 v32, v16, v16
    v_fmac_f32 v33, v17, v17
    v_fmac_f32 v34, v18, v18
    v_fmac_f32 v35, v19, v19
    v_fmac_f32 v36, v20, v20
    v_fmac_f32 v37, v21, v21
    v_fmac_f32 v38, v22, v22
    v_fmac_f32 v39, v23, v23
    ds_write_b128 v248, v[32:35]
    ds_write_b128 v248, v[36:39] offset:1024
    ds_write_b32 v253, v254 offset:24624
    v_mul_f32 v40, v8, v8
    v_mul_f32 v41, v9, v9
    v_mul_f32 v42, v10, v10
    v_mul_f32 v43, v11, v11
    v_mul_f32 v44, v12, v12
    v_mul_f32 v45, v13, v13
    v_mul_f32 v46, v14, v14
    v_mul_f32 v47, v15, v15
    v_fmac_f32 v40, v24, v24
    v_fmac_f32 v41, v25, v25
    v_fmac_f32 v42, v26, v26
    v_fmac_f32 v43, v27, v27
    v_fmac_f32 v44, v28, v28
    v_fmac_f32 v45, v29, v29
    v_fmac_f32 v46, v30, v30
    v_fmac_f32 v47, v31, v31
    s_nop 1
    s_branch CC_R1_0
CC_S1_0:
    ds_write_b128 v248, v[32:35]
    ds_write_b128 v248, v[36:39] offset:1024
    ds_write_b32 v253, v254 offset:24624
CC_R1_0:
    s_mov_b32 s27, 0
LS_EN1_0:
    s_nop 0
    ds_read_b32 v81, v80 offset:24624
    ds_read_b128 v[48:51], v249
    ds_read_b128 v[52:55], v249 offset:1024
    s_add_u32 s27, s27, 1
    s_waitcnt lgkmcnt(2)
    v_readfirstlane_b32 s16, v81
    s_cmp_gt_u32 s27, 0xc3500
    s_nop 3
    s_cbranch_scc1 LSX_EN1_0
    s_cmp_ge_u32 s16, 1
    s_cbranch_scc0 LS_EN1_0
LSX_EN1_0:
    s_waitcnt lgkmcnt(0)
    v_add_f32 v48, v48, v40
    v_add_f32 v49, v49, v41
    v_add_f32 v50, v50, v42
    v_add_f32 v51, v51, v43
    v_add_f32 v52, v52, v44
    v_add_f32 v53, v53, v45
    v_add_f32 v54, v54, v46
    v_add_f32 v55, v55, v47
    s_nop 1
CC_E2_0:
    s_nop 0
    v_cvt_pk_bf16_f32 v56, v48, v49
    v_cvt_pk_bf16_f32 v57, v50, v51
    v_cvt_pk_bf16_f32 v58, v52, v53
    v_cvt_pk_bf16_f32 v59, v54, v55
    v_or_b32 v56, 0x80008000, v56
    v_or_b32 v57, 0x80008000, v57
    v_or_b32 v58, 0x80008000, v58
    v_or_b32 v59, 0x80008000, v59
    s_mov_b32 s27, 0
    s_nop 0
LW_CBS:
    ds_read_b32 v253, v255 offset:24600
    s_add_u32 s27, s27, 1
    s_waitcnt lgkmcnt(0)
    v_readfirstlane_b32 s16, v253
    s_cmp_gt_u32 s27, 0xc3500
    s_nop 3
    s_cbranch_scc1 LWX_CBS
    s_cmp_ge_u32 s16, 4
    s_cbranch_scc1 LWX_CBS
    s_branch LW_CBS
LWX_CBS:
    buffer_store_dwordx4 v[56:59], v251, s[8:11], s44 offen sc1
    s_mov_b64 exec, 1
    ds_add_u32 v255, v82 offset:24596
    s_mov_b64 exec, -1
    s_add_u32 s44, s44, 0x100000
    s_mov_b32 s27, 0
LW_CH0:
    ds_read_b32 v253, v255 offset:24592
    s_add_u32 s27, s27, 1
    s_waitcnt lgkmcnt(0)
    v_readfirstlane_b32 s16, v253
    s_cmp_gt_u32 s27, 0xc3500
    s_nop 3
    s_cbranch_scc1 LWX_CH0
    s_cmp_ge_u32 s16, 1
    s_cbranch_scc1 LWX_CH0
    s_sleep 1
    s_branch LW_CH0
LWX_CH0:
    s_mov_b32 s27, 0
    s_sleep 12
C_POLL2_0:
    buffer_load_dwordx4 v[64:67], v252, s[8:11], s45 offen offset:0 sc1
    buffer_load_dwordx4 v[68:71], v252, s[8:11], s45 offen offset:16 sc1
    buffer_load_dwordx4 v[72:75], v252, s[8:11], s45 offen offset:2048 sc1
    buffer_load_dwordx4 v[76:79], v252, s[8:11], s45 offen offset:2064 sc1
    s_waitcnt vmcnt(0)
    s_nop 0
    v_bitop3_b32 v253, v64, v65, v66 bitop3:0x80
    v_bitop3_b32 v254, v67, v68, v69 bitop3:0x80
    v_bitop3_b32 v253, v253, v70, v71 bitop3:0x80
    v_bitop3_b32 v254, v254, v72, v73 bitop3:0x80
    v_bitop3_b32 v253, v253, v74, v75 bitop3:0x80
    v_bitop3_b32 v254, v254, v76, v77 bitop3:0x80
    v_bitop3_b32 v253, v253, v78, v79 bitop3:0x80
    v_and_b32 v253, v253, v254
    v_cmp_le_i32 vcc, 0, v253
    s_add_u32 s27, s27, 1
    s_cmp_gt_u32 s27, 20000
    s_nop 2
    s_cbranch_scc1 C_POLL2_0X
    s_cbranch_vccnz C_POLL2_0
C_POLL2_0X:
    s_add_u32 s45, s45, 0x10000
    v_mov_b32 v253, 1
    s_mov_b64 exec, 1
    ds_add_u32 v255, v253 offset:24668
    s_mov_b64 exec, -1
    s_nop 0
    v_fma_mixlo_f16 v96, v0, |v64|, 0
    v_fma_mixlo_f16 v97, v1, |v65|, 0
    v_fma_mixlo_f16 v98, v2, |v66|, 0
    v_fma_mixlo_f16 v99, v3, |v67|, 0
    v_fma_mixhi_f16 v96, v16, -|v64|, 0
    v_fma_mixhi_f16 v97, v17, -|v65|, 0
    v_fma_mixhi_f16 v98, v18, -|v66|, 0
    v_fma_mixhi_f16 v99, v19, -|v67|, 0
    v_fma_mixlo_f16 v100, v4, |v68|, 0
    v_fma_mixlo_f16 v101, v5, |v69|, 0
    v_mfma_f32_32x32x16_f16 v[32:47], v[96:99], v[144:147], 0
    v_fma_mixlo_f16 v102, v6, |v70|, 0
    v_fma_mixlo_f16 v103, v7, |v71|, 0
    v_fma_mixhi_f16 v100, v20, -|v68|, 0
    v_fma_mixhi_f16 v101, v21, -|v69|, 0
    v_mfma_f32_32x32x16_f16 v[48:63], v[96:99], v[160:163], 0
    v_fma_mixhi_f16 v102, v22, -|v70|, 0
    v_fma_mixhi_f16 v103, v23, -|v71|, 0
    v_fma_mixlo_f16 v104, v8, |v72|, 0
    v_fma_mixlo_f16 v105, v9, |v73|, 0
    v_mfma_f32_32x32x16_f16 v[32:47], v[100:103], v[148:151], v[32:47]
    v_fma_mixlo_f16 v106, v10, |v74|, 0
    v_fma_mixlo_f16 v107, v11, |v75|, 0
    v_fma_mixhi_f16 v104, v24, -|v72|, 0
    v_fma_mixhi_f16 v105, v25, -|v73|, 0
    v_mfma_f32_32x32x16_f16 v[48:63], v[100:103], v[164:167], v[48:63]
    v_fma_mixhi_f16 v106, v26, -|v74|, 0
    v_fma_mixhi_f16 v107, v27, -|v75|, 0
    v_fma_mixlo_f16 v108, v12, |v76|, 0
    v_fma_mixlo_f16 v109, v13, |v77|, 0
    v_mfma_f32_32x32x16_f16 v[32:47], v[104:107], v[152:155], v[32:47]
    v_fma_mixlo_f16 v110, v14, |v78|, 0
    v_fma_mixlo_f16 v111, v15, |v79|, 0
    v_fma_mixhi_f16 v108, v28, -|v76|, 0
    v_fma_mixhi_f16 v109, v29, -|v77|, 0
    v_mfma_f32_32x32x16_f16 v[48:63], v[104:107], v[168:171], v[48:63]
    v_fma_mixhi_f16 v110, v30, -|v78|, 0
    v_fma_mixhi_f16 v111, v31, -|v79|, 0
    s_nop 1
    v_mfma_f32_32x32x16_f16 v[32:47], v[108:111], v[156:159], v[32:47]
    v_mfma_f32_32x32x16_f16 v[48:63], v[108:111], v[172:175], v[48:63]
    s_nop 11
    v_cvt_pk_f16_f32 v112, v32, v48
    v_cvt_pk_f16_f32 v113, v33, v49
    v_cvt_pk_f16_f32 v114, v34, v50
    v_cvt_pk_f16_f32 v115, v35, v51
    v_pk_mul_f16 v96, v112, v128 op_sel:[0,0] op_sel_hi:[1,0]
    v_pk_mul_f16 v97, v113, v129 op_sel:[0,0] op_sel_hi:[1,0]
    v_pk_mul_f16 v98, v114, v130 op_sel:[0,0] op_sel_hi:[1,0]
    v_pk_mul_f16 v99, v115, v131 op_sel:[0,0] op_sel_hi:[1,0]
    v_pk_fma_f16 v96, v112, v128, v96 op_sel:[1,1,0] op_sel_hi:[0,1,1] neg_lo:[1,0,0]
    v_pk_fma_f16 v97, v113, v129, v97 op_sel:[1,1,0] op_sel_hi:[0,1,1] neg_lo:[1,0,0]
    v_pk_fma_f16 v98, v114, v130, v98 op_sel:[1,1,0] op_sel_hi:[0,1,1] neg_lo:[1,0,0]
    v_pk_fma_f16 v99, v115, v131, v99 op_sel:[1,1,0] op_sel_hi:[0,1,1] neg_lo:[1,0,0]
    v_cvt_pk_f16_f32 v116, v36, v52
    v_cvt_pk_f16_f32 v117, v37, v53
    v_mfma_f32_32x32x16_f16 v[64:79], v[144:147], v[96:99], 0
    v_cvt_pk_f16_f32 v118, v38, v54
    v_cvt_pk_f16_f32 v119, v39, v55
    v_pk_mul_f16 v100, v116, v132 op_sel:[0,0] op_sel_hi:[1,0]
    v_pk_mul_f16 v101, v117, v133 op_sel:[0,0] op_sel_hi:[1,0]
    v_pk_mul_f16 v102, v118, v134 op_sel:[0,0] op_sel_hi:[1,0]
    v_pk_mul_f16 v103, v119, v135 op_sel:[0,0] op_sel_hi:[1,0]
    v_mfma_f32_32x32x16_f16 v[80:95], v[160:163], v[96:99], 0
    v_pk_fma_f16 v100, v116, v132, v100 op_sel:[1,1,0] op_sel_hi:[0,1,1] neg_lo:[1,0,0]
    v_pk_fma_f16 v101, v117, v133, v101 op_sel:[1,1,0] op_sel_hi:[0,1,1] neg_lo:[1,0,0]
    v_pk_fma_f16 v102, v118, v134, v102 op_sel:[1,1,0] op_sel_hi:[0,1,1] neg_lo:[1,0,0]
    v_pk_fma_f16 v103, v119, v135, v103 op_sel:[1,1,0] op_sel_hi:[0,1,1] neg_lo:[1,0,0]
    v_cvt_pk_f16_f32 v120, v40, v56
    v_cvt_pk_f16_f32 v121, v41, v57
    v_mfma_f32_32x32x16_f16 v[64:79], v[148:151], v[100:103], v[64:79]
    v_cvt_pk_f16_f32 v122, v42, v58
    v_cvt_pk_f16_f32 v123, v43, v59
    v_pk_mul_f16 v104, v120, v136 op_sel:[0,0] op_sel_hi:[1,0]
    v_pk_mul_f16 v105, v121, v137 op_sel:[0,0] op_sel_hi:[1,0]
    v_pk_mul_f16 v106, v122, v138 op_sel:[0,0] op_sel_hi:[1,0]
    v_pk_mul_f16 v107, v123, v139 op_sel:[0,0] op_sel_hi:[1,0]
    v_mfma_f32_32x32x16_f16 v[80:95], v[164:167], v[100:103], v[80:95]
    v_pk_fma_f16 v104, v120, v136, v104 op_sel:[1,1,0] op_sel_hi:[0,1,1] neg_lo:[1,0,0]
    v_pk_fma_f16 v105, v121, v137, v105 op_sel:[1,1,0] op_sel_hi:[0,1,1] neg_lo:[1,0,0]
    v_pk_fma_f16 v106, v122, v138, v106 op_sel:[1,1,0] op_sel_hi:[0,1,1] neg_lo:[1,0,0]
    v_pk_fma_f16 v107, v123, v139, v107 op_sel:[1,1,0] op_sel_hi:[0,1,1] neg_lo:[1,0,0]
    v_cvt_pk_f16_f32 v124, v44, v60
    v_cvt_pk_f16_f32 v125, v45, v61
    v_mfma_f32_32x32x16_f16 v[64:79], v[152:155], v[104:107], v[64:79]
    v_cvt_pk_f16_f32 v126, v46, v62
    v_cvt_pk_f16_f32 v127, v47, v63
    v_pk_mul_f16 v108, v124, v140 op_sel:[0,0] op_sel_hi:[1,0]
    v_pk_mul_f16 v109, v125, v141 op_sel:[0,0] op_sel_hi:[1,0]
    v_pk_mul_f16 v110, v126, v142 op_sel:[0,0] op_sel_hi:[1,0]
    v_pk_mul_f16 v111, v127, v143 op_sel:[0,0] op_sel_hi:[1,0]
    v_mfma_f32_32x32x16_f16 v[80:95], v[168:171], v[104:107], v[80:95]
    v_pk_fma_f16 v108, v124, v140, v108 op_sel:[1,1,0] op_sel_hi:[0,1,1] neg_lo:[1,0,0]
    v_pk_fma_f16 v109, v125, v141, v109 op_sel:[1,1,0] op_sel_hi:[0,1,1] neg_lo:[1,0,0]
    v_pk_fma_f16 v110, v126, v142, v110 op_sel:[1,1,0] op_sel_hi:[0,1,1] neg_lo:[1,0,0]
    v_pk_fma_f16 v111, v127, v143, v111 op_sel:[1,1,0] op_sel_hi:[0,1,1] neg_lo:[1,0,0]
    s_nop 1
    v_mfma_f32_32x32x16_f16 v[64:79], v[156:159], v[108:111], v[64:79]
    v_mfma_f32_32x32x16_f16 v[80:95], v[172:175], v[108:111], v[80:95]
    v_mov_b32 v253, s28
    v_mov_b32 v254, 2
    s_nop 9
    v_cvt_pk_f16_f32 v96, v64, v80
    v_cvt_pk_f16_f32 v97, v65, v81
    v_cvt_pk_f16_f32 v98, v66, v82
    v_cvt_pk_f16_f32 v99, v67, v83
    ds_write_b128 v245, v[96:99] offset:0
    v_cvt_pk_f16_f32 v100, v68, v84
    v_cvt_pk_f16_f32 v101, v69, v85
    v_cvt_pk_f16_f32 v102, v70, v86
    v_cvt_pk_f16_f32 v103, v71, v87
    ds_write_b128 v245, v[100:103] offset:1024
    v_cvt_pk_f16_f32 v104, v72, v88
    v_cvt_pk_f16_f32 v105, v73, v89
    v_cvt_pk_f16_f32 v106, v74, v90
    v_cvt_pk_f16_f32 v107, v75, v91
    ds_write_b128 v245, v[104:107] offset:2048
    v_cvt_pk_f16_f32 v108, v76, v92
    v_cvt_pk_f16_f32 v109, v77, v93
    v_cvt_pk_f16_f32 v110, v78, v94
    v_cvt_pk_f16_f32 v111, v79, v95
    ds_write_b128 v245, v[108:111] offset:3072
    ds_write_b32 v253, v254 offset:24608
    s_add_u32 s16, s46, 44288
    v_add_u32 v32, s16, v244
    s_add_u32 s16, s47, 44288
    v_add_u32 v33, s16, v244
    s_mov_b32 s27, 0
    s_nop 0
LW_PQ1:
    ds_read_b32 v254, v255 offset:24588
    s_add_u32 s27, s27, 1
    s_waitcnt lgkmcnt(0)
    v_readfirstlane_b32 s16, v254
    s_cmp_gt_u32 s27, 0xc3500
    s_nop 3
    s_cbranch_scc1 LWX_PQ1
    s_cmp_ge_u32 s16, 8
    s_cbranch_scc1 LWX_PQ1
    s_sleep 1
    s_branch LW_PQ1
LWX_PQ1:
    s_nop 0
    ds_read_b32 v34, v255 offset:24580
    ds_read_b128 v[208:211], v32 offset:0
    ds_read_b128 v[212:215], v32 offset:1024
    ds_read_b128 v[216:219], v32 offset:2048
    ds_read_b128 v[220:223], v32 offset:3072
    ds_read_b128 v[224:227], v33 offset:0
    ds_read_b128 v[228:231], v33 offset:1024
    ds_read_b128 v[232:235], v33 offset:2048
    ds_read_b128 v[236:239], v33 offset:3072
    s_waitcnt lgkmcnt(4)
    s_nop 0
    v_pk_mul_f16 v64, v96, v208 op_sel:[0,0] op_sel_hi:[1,0] neg_hi:[1,0]
    v_pk_mul_f16 v65, v97, v209 op_sel:[0,0] op_sel_hi:[1,0] neg_hi:[1,0]
    v_pk_mul_f16 v66, v98, v210 op_sel:[0,0] op_sel_hi:[1,0] neg_hi:[1,0]
    v_pk_mul_f16 v67, v99, v211 op_sel:[0,0] op_sel_hi:[1,0] neg_hi:[1,0]
    v_pk_mul_f16 v68, v100, v212 op_sel:[0,0] op_sel_hi:[1,0] neg_hi:[1,0]
    v_pk_mul_f16 v69, v101, v213 op_sel:[0,0] op_sel_hi:[1,0] neg_hi:[1,0]
    v_pk_mul_f16 v70, v102, v214 op_sel:[0,0] op_sel_hi:[1,0] neg_hi:[1,0]
    v_pk_mul_f16 v71, v103, v215 op_sel:[0,0] op_sel_hi:[1,0] neg_hi:[1,0]
    v_mov_b32_e64 v253, s29
    ds_read_b32 v254, v253 offset:24608
    ds_read_b128 v[112:115], v247 offset:0
    ds_read_b128 v[116:119], v247 offset:1024
    ds_read_b128 v[120:123], v247 offset:2048
    ds_read_b128 v[124:127], v247 offset:3072
    v_pk_mul_f16 v72, v104, v216 op_sel:[0,0] op_sel_hi:[1,0] neg_hi:[1,0]
    v_pk_mul_f16 v73, v105, v217 op_sel:[0,0] op_sel_hi:[1,0] neg_hi:[1,0]
    v_pk_mul_f16 v74, v106, v218 op_sel:[0,0] op_sel_hi:[1,0] neg_hi:[1,0]
    v_pk_mul_f16 v75, v107, v219 op_sel:[0,0] op_sel_hi:[1,0] neg_hi:[1,0]
    v_pk_mul_f16 v76, v108, v220 op_sel:[0,0] op_sel_hi:[1,0] neg_hi:[1,0]
    v_pk_mul_f16 v77, v109, v221 op_sel:[0,0] op_sel_hi:[1,0] neg_hi:[1,0]
    v_pk_mul_f16 v78, v110, v222 op_sel:[0,0] op_sel_hi:[1,0] neg_hi:[1,0]
    v_pk_mul_f16 v79, v111, v223 op_sel:[0,0] op_sel_hi:[1,0] neg_hi:[1,0]
    v_pk_fma_f16 v64, v96, v208, v64 op_sel:[1,1,0] op_sel_hi:[0,1,1] neg_lo:[1,0,0] neg_hi:[1,0,0]
    v_pk_fma_f16 v65, v97, v209, v65 op_sel:[1,1,0] op_sel_hi:[0,1,1] neg_lo:[1,0,0] neg_hi:[1,0,0]
    v_pk_fma_f16 v66, v98, v210, v66 op_sel:[1,1,0] op_sel_hi:[0,1,1] neg_lo:[1,0,0] neg_hi:[1,0,0]
    v_pk_fma_f16 v67, v99, v211, v67 op_sel:[1,1,0] op_sel_hi:[0,1,1] neg_lo:[1,0,0] neg_hi:[1,0,0]
    v_pk_fma_f16 v68, v100, v212, v68 op_sel:[1,1,0] op_sel_hi:[0,1,1] neg_lo:[1,0,0] neg_hi:[1,0,0]
    v_pk_fma_f16 v69, v101, v213, v69 op_sel:[1,1,0] op_sel_hi:[0,1,1] neg_lo:[1,0,0] neg_hi:[1,0,0]
    v_pk_fma_f16 v70, v102, v214, v70 op_sel:[1,1,0] op_sel_hi:[0,1,1] neg_lo:[1,0,0] neg_hi:[1,0,0]
    v_pk_fma_f16 v71, v103, v215, v71 op_sel:[1,1,0] op_sel_hi:[0,1,1] neg_lo:[1,0,0] neg_hi:[1,0,0]
    v_pk_fma_f16 v72, v104, v216, v72 op_sel:[1,1,0] op_sel_hi:[0,1,1] neg_lo:[1,0,0] neg_hi:[1,0,0]
    v_pk_fma_f16 v73, v105, v217, v73 op_sel:[1,1,0] op_sel_hi:[0,1,1] neg_lo:[1,0,0] neg_hi:[1,0,0]
    v_pk_fma_f16 v74, v106, v218, v74 op_sel:[1,1,0] op_sel_hi:[0,1,1] neg_lo:[1,0,0] neg_hi:[1,0,0]
    v_pk_fma_f16 v75, v107, v219, v75 op_sel:[1,1,0] op_sel_hi:[0,1,1] neg_lo:[1,0,0] neg_hi:[1,0,0]
    v_pk_fma_f16 v76, v108, v220, v76 op_sel:[1,1,0] op_sel_hi:[0,1,1] neg_lo:[1,0,0] neg_hi:[1,0,0]
    v_pk_fma_f16 v77, v109, v221, v77 op_sel:[1,1,0] op_sel_hi:[0,1,1] neg_lo:[1,0,0] neg_hi:[1,0,0]
    v_pk_fma_f16 v78, v110, v222, v78 op_sel:[1,1,0] op_sel_hi:[0,1,1] neg_lo:[1,0,0] neg_hi:[1,0,0]
    v_pk_fma_f16 v79, v111, v223, v79 op_sel:[1,1,0] op_sel_hi:[0,1,1] neg_lo:[1,0,0] neg_hi:[1,0,0]
    s_waitcnt lgkmcnt(4)
    v_readfirstlane_b32 s16, v254
    s_nop 0
    s_cmp_ge_u32 s16, 2
    s_nop 2
    s_cbranch_scc1 C_XOK_1
    s_mov_b32 s27, 0
LS_X1:
    s_nop 0
    ds_read_b32 v254, v253 offset:24608
    ds_read_b128 v[112:115], v247 offset:0
    ds_read_b128 v[116:119], v247 offset:1024
    ds_read_b128 v[120:123], v247 offset:2048
    ds_read_b128 v[124:127], v247 offset:3072
    s_add_u32 s27, s27, 1
    s_waitcnt lgkmcnt(4)
    v_readfirstlane_b32 s16, v254
    s_cmp_gt_u32 s27, 0xc3500
    s_nop 3
    s_cbranch_scc1 LSX_X1
    s_cmp_ge_u32 s16, 2
    s_cbranch_scc0 LS_X1
LSX_X1:
C_XOK_1:
    s_waitcnt lgkmcnt(3)
    v_pk_fma_f16 v64, v112, v224, v64 op_sel:[0,0,0] op_sel_hi:[1,0,1] neg_hi:[1,0,0]
    v_pk_fma_f16 v65, v113, v225, v65 op_sel:[0,0,0] op_sel_hi:[1,0,1] neg_hi:[1,0,0]
    v_pk_fma_f16 v66, v114, v226, v66 op_sel:[0,0,0] op_sel_hi:[1,0,1] neg_hi:[1,0,0]
    v_pk_fma_f16 v67, v115, v227, v67 op_sel:[0,0,0] op_sel_hi:[1,0,1] neg_hi:[1,0,0]
    v_pk_fma_f16 v64, v112, v224, v64 op_sel:[1,1,0] op_sel_hi:[0,1,1] neg_lo:[1,0,0] neg_hi:[1,0,0]
    v_pk_fma_f16 v65, v113, v225, v65 op_sel:[1,1,0] op_sel_hi:[0,1,1] neg_lo:[1,0,0] neg_hi:[1,0,0]
    v_pk_fma_f16 v66, v114, v226, v66 op_sel:[1,1,0] op_sel_hi:[0,1,1] neg_lo:[1,0,0] neg_hi:[1,0,0]
    v_pk_fma_f16 v67, v115, v227, v67 op_sel:[1,1,0] op_sel_hi:[0,1,1] neg_lo:[1,0,0] neg_hi:[1,0,0]
    s_waitcnt lgkmcnt(2)
    s_nop 0
    v_pk_fma_f16 v68, v116, v228, v68 op_sel:[0,0,0] op_sel_hi:[1,0,1] neg_hi:[1,0,0]
    v_mfma_f32_32x32x16_f16 v[32:47], v[64:67], v[144:147], 0
    v_pk_fma_f16 v69, v117, v229, v69 op_sel:[0,0,0] op_sel_hi:[1,0,1] neg_hi:[1,0,0]
    v_pk_fma_f16 v70, v118, v230, v70 op_sel:[0,0,0] op_sel_hi:[1,0,1] neg_hi:[1,0,0]
    v_pk_fma_f16 v71, v119, v231, v71 op_sel:[0,0,0] op_sel_hi:[1,0,1] neg_hi:[1,0,0]
    v_pk_fma_f16 v68, v116, v228, v68 op_sel:[1,1,0] op_sel_hi:[0,1,1] neg_lo:[1,0,0] neg_hi:[1,0,0]
    v_mfma_f32_32x32x16_f16 v[48:63], v[64:67], v[160:163], 0
    v_pk_fma_f16 v69, v117, v229, v69 op_sel:[1,1,0] op_sel_hi:[0,1,1] neg_lo:[1,0,0] neg_hi:[1,0,0]
    v_pk_fma_f16 v70, v118, v230, v70 op_sel:[1,1,0] op_sel_hi:[0,1,1] neg_lo:[1,0,0] neg_hi:[1,0,0]
    v_pk_fma_f16 v71, v119, v231, v71 op_sel:[1,1,0] op_sel_hi:[0,1,1] neg_lo:[1,0,0] neg_hi:[1,0,0]
    s_waitcnt lgkmcnt(1)
    s_nop 0
    v_pk_fma_f16 v72, v120, v232, v72 op_sel:[0,0,0] op_sel_hi:[1,0,1] neg_hi:[1,0,0]
    v_mfma_f32_32x32x16_f16 v[32:47], v[68:71], v[148:151], v[32:47]
    v_pk_fma_f16 v73, v121, v233, v73 op_sel:[0,0,0] op_sel_hi:[1,0,1] neg_hi:[1,0,0]
    v_pk_fma_f16 v74, v122, v234, v74 op_sel:[0,0,0] op_sel_hi:[1,0,1] neg_hi:[1,0,0]
    v_pk_fma_f16 v75, v123, v235, v75 op_sel:[0,0,0] op_sel_hi:[1,0,1] neg_hi:[1,0,0]
    v_pk_fma_f16 v72, v120, v232, v72 op_sel:[1,1,0] op_sel_hi:[0,1,1] neg_lo:[1,0,0] neg_hi:[1,0,0]
    v_mfma_f32_32x32x16_f16 v[48:63], v[68:71], v[164:167], v[48:63]
    v_pk_fma_f16 v73, v121, v233, v73 op_sel:[1,1,0] op_sel_hi:[0,1,1] neg_lo:[1,0,0] neg_hi:[1,0,0]
    v_pk_fma_f16 v74, v122, v234, v74 op_sel:[1,1,0] op_sel_hi:[0,1,1] neg_lo:[1,0,0] neg_hi:[1,0,0]
    v_pk_fma_f16 v75, v123, v235, v75 op_sel:[1,1,0] op_sel_hi:[0,1,1] neg_lo:[1,0,0] neg_hi:[1,0,0]
    s_waitcnt lgkmcnt(0)
    s_nop 0
    v_pk_fma_f16 v76, v124, v236, v76 op_sel:[0,0,0] op_sel_hi:[1,0,1] neg_hi:[1,0,0]
    v_mfma_f32_32x32x16_f16 v[32:47], v[72:75], v[152:155], v[32:47]
    v_pk_fma_f16 v77, v125, v237, v77 op_sel:[0,0,0] op_sel_hi:[1,0,1] neg_hi:[1,0,0]
    v_pk_fma_f16 v78, v126, v238, v78 op_sel:[0,0,0] op_sel_hi:[1,0,1] neg_hi:[1,0,0]
    v_pk_fma_f16 v79, v127, v239, v79 op_sel:[0,0,0] op_sel_hi:[1,0,1] neg_hi:[1,0,0]
    v_pk_fma_f16 v76, v124, v236, v76 op_sel:[1,1,0] op_sel_hi:[0,1,1] neg_lo:[1,0,0] neg_hi:[1,0,0]
    v_mfma_f32_32x32x16_f16 v[48:63], v[72:75], v[168:171], v[48:63]
    v_pk_fma_f16 v77, v125, v237, v77 op_sel:[1,1,0] op_sel_hi:[0,1,1] neg_lo:[1,0,0] neg_hi:[1,0,0]
    v_pk_fma_f16 v78, v126, v238, v78 op_sel:[1,1,0] op_sel_hi:[0,1,1] neg_lo:[1,0,0] neg_hi:[1,0,0]
    v_pk_fma_f16 v79, v127, v239, v79 op_sel:[1,1,0] op_sel_hi:[0,1,1] neg_lo:[1,0,0] neg_hi:[1,0,0]
    s_nop 1
    v_mfma_f32_32x32x16_f16 v[32:47], v[76:79], v[156:159], v[32:47]
    v_mfma_f32_32x32x16_f16 v[48:63], v[76:79], v[172:175], v[48:63]
    s_nop 11
    v_cvt_pk_f16_f32 v112, v32, v48
    v_cvt_pk_f16_f32 v113, v33, v49
    v_cvt_pk_f16_f32 v114, v34, v50
    v_cvt_pk_f16_f32 v115, v35, v51
    v_pk_mul_f16 v96, v112, v128 op_sel:[0,0] op_sel_hi:[1,0]
    v_pk_mul_f16 v97, v113, v129 op_sel:[0,0] op_sel_hi:[1,0]
    v_pk_mul_f16 v98, v114, v130 op_sel:[0,0] op_sel_hi:[1,0]
    v_pk_mul_f16 v99, v115, v131 op_sel:[0,0] op_sel_hi:[1,0]
    v_pk_fma_f16 v96, v112, v128, v96 op_sel:[1,1,0] op_sel_hi:[0,1,1] neg_lo:[1,0,0]
    v_pk_fma_f16 v97, v113, v129, v97 op_sel:[1,1,0] op_sel_hi:[0,1,1] neg_lo:[1,0,0]
    v_pk_fma_f16 v98, v114, v130, v98 op_sel:[1,1,0] op_sel_hi:[0,1,1] neg_lo:[1,0,0]
    v_pk_fma_f16 v99, v115, v131, v99 op_sel:[1,1,0] op_sel_hi:[0,1,1] neg_lo:[1,0,0]
    v_cvt_pk_f16_f32 v116, v36, v52
    v_cvt_pk_f16_f32 v117, v37, v53
    v_mfma_f32_32x32x16_f16 v[0:15], v[144:147], v[96:99], v[0:15]
    v_cvt_pk_f16_f32 v118, v38, v54
    v_cvt_pk_f16_f32 v119, v39, v55
    v_pk_mul_f16 v100, v116, v132 op_sel:[0,0] op_sel_hi:[1,0]
    v_pk_mul_f16 v101, v117, v133 op_sel:[0,0] op_sel_hi:[1,0]
    v_pk_mul_f16 v102, v118, v134 op_sel:[0,0] op_sel_hi:[1,0]
    v_pk_mul_f16 v103, v119, v135 op_sel:[0,0] op_sel_hi:[1,0]
    v_mfma_f32_32x32x16_f16 v[16:31], v[160:163], v[96:99], v[16:31]
    v_pk_fma_f16 v100, v116, v132, v100 op_sel:[1,1,0] op_sel_hi:[0,1,1] neg_lo:[1,0,0]
    v_pk_fma_f16 v101, v117, v133, v101 op_sel:[1,1,0] op_sel_hi:[0,1,1] neg_lo:[1,0,0]
    v_pk_fma_f16 v102, v118, v134, v102 op_sel:[1,1,0] op_sel_hi:[0,1,1] neg_lo:[1,0,0]
    v_pk_fma_f16 v103, v119, v135, v103 op_sel:[1,1,0] op_sel_hi:[0,1,1] neg_lo:[1,0,0]
    v_cvt_pk_f16_f32 v120, v40, v56
    v_cvt_pk_f16_f32 v121, v41, v57
    v_mfma_f32_32x32x16_f16 v[0:15], v[148:151], v[100:103], v[0:15]
    v_cvt_pk_f16_f32 v122, v42, v58
    v_cvt_pk_f16_f32 v123, v43, v59
    v_pk_mul_f16 v104, v120, v136 op_sel:[0,0] op_sel_hi:[1,0]
    v_pk_mul_f16 v105, v121, v137 op_sel:[0,0] op_sel_hi:[1,0]
    v_pk_mul_f16 v106, v122, v138 op_sel:[0,0] op_sel_hi:[1,0]
    v_pk_mul_f16 v107, v123, v139 op_sel:[0,0] op_sel_hi:[1,0]
    v_mfma_f32_32x32x16_f16 v[16:31], v[164:167], v[100:103], v[16:31]
    v_pk_fma_f16 v104, v120, v136, v104 op_sel:[1,1,0] op_sel_hi:[0,1,1] neg_lo:[1,0,0]
    v_pk_fma_f16 v105, v121, v137, v105 op_sel:[1,1,0] op_sel_hi:[0,1,1] neg_lo:[1,0,0]
    v_pk_fma_f16 v106, v122, v138, v106 op_sel:[1,1,0] op_sel_hi:[0,1,1] neg_lo:[1,0,0]
    v_pk_fma_f16 v107, v123, v139, v107 op_sel:[1,1,0] op_sel_hi:[0,1,1] neg_lo:[1,0,0]
    v_cvt_pk_f16_f32 v124, v44, v60
    v_cvt_pk_f16_f32 v125, v45, v61
    v_mfma_f32_32x32x16_f16 v[0:15], v[152:155], v[104:107], v[0:15]
    v_cvt_pk_f16_f32 v126, v46, v62
    v_cvt_pk_f16_f32 v127, v47, v63
    v_pk_mul_f16 v108, v124, v140 op_sel:[0,0] op_sel_hi:[1,0]
    v_pk_mul_f16 v109, v125, v141 op_sel:[0,0] op_sel_hi:[1,0]
    v_pk_mul_f16 v110, v126, v142 op_sel:[0,0] op_sel_hi:[1,0]
    v_pk_mul_f16 v111, v127, v143 op_sel:[0,0] op_sel_hi:[1,0]
    v_mfma_f32_32x32x16_f16 v[16:31], v[168:171], v[104:107], v[16:31]
    v_pk_fma_f16 v108, v124, v140, v108 op_sel:[1,1,0] op_sel_hi:[0,1,1] neg_lo:[1,0,0]
    v_pk_fma_f16 v109, v125, v141, v109 op_sel:[1,1,0] op_sel_hi:[0,1,1] neg_lo:[1,0,0]
    v_pk_fma_f16 v110, v126, v142, v110 op_sel:[1,1,0] op_sel_hi:[0,1,1] neg_lo:[1,0,0]
    v_pk_fma_f16 v111, v127, v143, v111 op_sel:[1,1,0] op_sel_hi:[0,1,1] neg_lo:[1,0,0]
    s_nop 1
    v_mfma_f32_32x32x16_f16 v[0:15], v[156:159], v[108:111], v[0:15]
    v_mfma_f32_32x32x16_f16 v[16:31], v[172:175], v[108:111], v[16:31]
    v_mov_b32 v253, s28
    v_mov_b32 v254, 2
    v_mov_b32 v80, s30
    v_mov_b32 v82, 1
    s_cmp_lg_u32 s14, 387
    s_nop 6
    s_cbranch_scc1 CC_REG_1
    v_mov_b32 v16, 0
    v_mov_b32 v17, 0
    v_mov_b32 v18, 0
    v_mov_b32 v19, 0
    v_mov_b32 v20, 0
    v_mov_b32 v21, 0
    v_mov_b32 v22, 0
    v_mov_b32 v23, 0
    v_mov_b32 v24, 0
    v_mov_b32 v25, 0
    v_mov_b32 v26, 0
    v_mov_b32 v27, 0
    v_mov_b32 v28, 0
    v_mov_b32 v29, 0
    v_mov_b32 v30, 0
    v_mov_b32_e64 v31, 0
    v_mul_f32 v48, 0x3f3504f3, v0
    v_mul_f32 v49, 0x3f3504f3, v1
    v_mul_f32 v50, 0x3f3504f3, v2
    v_mul_f32 v51, 0x3f3504f3, v3
    v_mul_f32 v52, 0x3f3504f3, v4
    v_mul_f32 v53, 0x3f3504f3, v5
    v_mul_f32 v54, 0x3f3504f3, v6
    v_mul_f32 v55, 0x3f3504f3, v7
    v_mul_f32 v56, 0x3f3504f3, v8
    v_mul_f32 v57, 0x3f3504f3, v9
    v_mul_f32 v58, 0x3f3504f3, v10
    v_mul_f32 v59, 0x3f3504f3, v11
    v_mul_f32 v60, 0x3f3504f3, v12
    v_mul_f32 v61, 0x3f3504f3, v13
    v_mul_f32 v62, 0x3f3504f3, v14
    v_mul_f32 v63, 0x3f3504f3, v15
    v_mul_f32 v32, v48, v48
    v_mul_f32 v33, v49, v49
    v_mul_f32 v34, v50, v50
    v_mul_f32 v35, v51, v51
    v_mul_f32 v36, v52, v52
    v_mul_f32 v37, v53, v53
    v_mul_f32 v38, v54, v54
    v_mul_f32 v39, v55, v55
    v_mul_f32 v40, v56, v56
    v_mul_f32 v41, v57, v57
    v_mul_f32 v42, v58, v58
    v_mul_f32 v43, v59, v59
    v_mul_f32 v44, v60, v60
    v_mul_f32 v45, v61, v61
    v_mul_f32 v46, v62, v62
    v_mul_f32 v47, v63, v63
    s_cmp_eq_u32 s13, 0
    s_nop 0
    s_cbranch_scc1 CC_S0_1
    s_branch CC_S1_1
CC_REG_1:
    s_cmp_eq_u32 s13, 0
    s_cbranch_scc0 CC_E1_1
    v_mul_f32 v40, v8, v8
    v_mul_f32 v41, v9, v9
    v_mul_f32 v42, v10, v10
    v_mul_f32 v43, v11, v11
    v_mul_f32 v44, v12, v12
    v_mul_f32 v45, v13, v13
    v_mul_f32 v46, v14, v14
    v_mul_f32 v47, v15, v15
    v_fmac_f32 v40, v24, v24
    v_fmac_f32 v41, v25, v25
    v_fmac_f32 v42, v26, v26
    v_fmac_f32 v43, v27, v27
    v_fmac_f32 v44, v28, v28
    v_fmac_f32 v45, v29, v29
    v_fmac_f32 v46, v30, v30
    v_fmac_f32 v47, v31, v31
    ds_write_b128 v248, v[40:43]
    ds_write_b128 v248, v[44:47] offset:1024
    ds_write_b32 v253, v254 offset:24624
    v_mul_f32 v32, v0, v0
    v_mul_f32 v33, v1, v1
    v_mul_f32 v34, v2, v2
    v_mul_f32 v35, v3, v3
    v_mul_f32 v36, v4, v4
    v_mul_f32 v37, v5, v5
    v_mul_f32 v38, v6, v6
    v_mul_f32 v39, v7, v7
    v_fmac_f32 v32, v16, v16
    v_fmac_f32 v33, v17, v17
    v_fmac_f32 v34, v18, v18
    v_fmac_f32 v35, v19, v19
    v_fmac_f32 v36, v20, v20
    v_fmac_f32 v37, v21, v21
    v_fmac_f32 v38, v22, v22
    v_fmac_f32 v39, v23, v23
    s_nop 1
    s_branch CC_R0_1
CC_S0_1:
    ds_write_b128 v248, v[40:43]
    ds_write_b128 v248, v[44:47] offset:1024
    ds_write_b32 v253, v254 offset:24624
CC_R0_1:
    s_mov_b32 s27, 0
LS_EN0_1:
    s_nop 0
    ds_read_b32 v81, v80 offset:24624
    ds_read_b128 v[48:51], v249
    ds_read_b128 v[52:55], v249 offset:1024
    s_add_u32 s27, s27, 1
    s_waitcnt lgkmcnt(2)
    v_readfirstlane_b32 s16, v81
    s_cmp_gt_u32 s27, 0xc3500
    s_nop 3
    s_cbranch_scc1 LSX_EN0_1
    s_cmp_ge_u32 s16, 2
    s_cbranch_scc0 LS_EN0_1
LSX_EN0_1:
    s_waitcnt lgkmcnt(0)
    v_add_f32 v48, v48, v32
    v_add_f32 v49, v49, v33
    v_add_f32 v50, v50, v34
    v_add_f32 v51, v51, v35
    v_add_f32 v52, v52, v36
    v_add_f32 v53, v53, v37
    v_add_f32 v54, v54, v38
    v_add_f32 v55, v55, v39
    s_nop 1
    s_branch CC_E2_1
CC_E1_1:
    v_mul_f32 v32, v0, v0
    v_mul_f32 v33, v1, v1
    v_mul_f32 v34, v2, v2
    v_mul_f32 v35, v3, v3
    v_mul_f32 v36, v4, v4
    v_mul_f32 v37, v5, v5
    v_mul_f32 v38, v6, v6
    v_mul_f32 v39, v7, v7
    v_fmac_f32 v32, v16, v16
    v_fmac_f32 v33, v17, v17
    v_fmac_f32 v34, v18, v18
    v_fmac_f32 v35, v19, v19
    v_fmac_f32 v36, v20, v20
    v_fmac_f32 v37, v21, v21
    v_fmac_f32 v38, v22, v22
    v_fmac_f32 v39, v23, v23
    ds_write_b128 v248, v[32:35]
    ds_write_b128 v248, v[36:39] offset:1024
    ds_write_b32 v253, v254 offset:24624
    v_mul_f32 v40, v8, v8
    v_mul_f32 v41, v9, v9
    v_mul_f32 v42, v10, v10
    v_mul_f32 v43, v11, v11
    v_mul_f32 v44, v12, v12
    v_mul_f32 v45, v13, v13
    v_mul_f32 v46, v14, v14
    v_mul_f32 v47, v15, v15
    v_fmac_f32 v40, v24, v24
    v_fmac_f32 v41, v25, v25
    v_fmac_f32 v42, v26, v26
    v_fmac_f32 v43, v27, v27
    v_fmac_f32 v44, v28, v28
    v_fmac_f32 v45, v29, v29
    v_fmac_f32 v46, v30, v30
    v_fmac_f32 v47, v31, v31
    s_nop 1
    s_branch CC_R1_1
CC_S1_1:
    ds_write_b128 v248, v[32:35]
    ds_write_b128 v248, v[36:39] offset:1024
    ds_write_b32 v253, v254 offset:24624
CC_R1_1:
    s_mov_b32 s27, 0
LS_EN1_1:
    s_nop 0
    ds_read_b32 v81, v80 offset:24624
    ds_read_b128 v[48:51], v249
    ds_read_b128 v[52:55], v249 offset:1024
    s_add_u32 s27, s27, 1
    s_waitcnt lgkmcnt(2)
    v_readfirstlane_b32 s16, v81
    s_cmp_gt_u32 s27, 0xc3500
    s_nop 3
    s_cbranch_scc1 LSX_EN1_1
    s_cmp_ge_u32 s16, 2
    s_cbranch_scc0 LS_EN1_1
LSX_EN1_1:
    s_waitcnt lgkmcnt(0)
    v_add_f32 v48, v48, v40
    v_add_f32 v49, v49, v41
    v_add_f32 v50, v50, v42
    v_add_f32 v51, v51, v43
    v_add_f32 v52, v52, v44
    v_add_f32 v53, v53, v45
    v_add_f32 v54, v54, v46
    v_add_f32 v55, v55, v47
    s_nop 1
CC_E2_1:
    s_nop 0
    v_cvt_pk_bf16_f32 v56, v48, v49
    v_cvt_pk_bf16_f32 v57, v50, v51
    v_cvt_pk_bf16_f32 v58, v52, v53
    v_cvt_pk_bf16_f32 v59, v54, v55
    v_or_b32 v56, 0x80008000, v56
    v_or_b32 v57, 0x80008000, v57
    v_or_b32 v58, 0x80008000, v58
    v_or_b32 v59, 0x80008000, v59
    buffer_store_dwordx4 v[56:59], v251, s[8:11], s44 offen sc1
    s_mov_b64 exec, 1
    ds_add_u32 v255, v82 offset:24596
    s_mov_b64 exec, -1
    s_add_u32 s44, s44, 0x100000
    s_mov_b32 s27, 0
LW_CH1:
    ds_read_b32 v253, v255 offset:24592
    s_add_u32 s27, s27, 1
    s_waitcnt lgkmcnt(0)
    v_readfirstlane_b32 s16, v253
    s_cmp_gt_u32 s27, 0xc3500
    s_nop 3
    s_cbranch_scc1 LWX_CH1
    s_cmp_ge_u32 s16, 2
    s_cbranch_scc1 LWX_CH1
    s_sleep 1
    s_branch LW_CH1
LWX_CH1:
    s_mov_b32 s27, 0
    s_sleep 12
C_POLL2_1:
    buffer_load_dwordx4 v[64:67], v252, s[8:11], s45 offen offset:0 sc1
    buffer_load_dwordx4 v[68:71], v252, s[8:11], s45 offen offset:16 sc1
    buffer_load_dwordx4 v[72:75], v252, s[8:11], s45 offen offset:2048 sc1
    buffer_load_dwordx4 v[76:79], v252, s[8:11], s45 offen offset:2064 sc1
    s_waitcnt vmcnt(0)
    s_nop 0
    v_bitop3_b32 v253, v64, v65, v66 bitop3:0x80
    v_bitop3_b32 v254, v67, v68, v69 bitop3:0x80
    v_bitop3_b32 v253, v253, v70, v71 bitop3:0x80
    v_bitop3_b32 v254, v254, v72, v73 bitop3:0x80
    v_bitop3_b32 v253, v253, v74, v75 bitop3:0x80
    v_bitop3_b32 v254, v254, v76, v77 bitop3:0x80
    v_bitop3_b32 v253, v253, v78, v79 bitop3:0x80
    v_and_b32 v253, v253, v254
    v_cmp_le_i32 vcc, 0, v253
    s_add_u32 s27, s27, 1
    s_cmp_gt_u32 s27, 20000
    s_nop 2
    s_cbranch_scc1 C_POLL2_1X
    s_cbranch_vccnz C_POLL2_1
C_POLL2_1X:
    s_add_u32 s45, s45, 0x10000
    v_mov_b32 v253, 1
    s_mov_b64 exec, 1
    ds_add_u32 v255, v253 offset:24668
    s_mov_b64 exec, -1
    s_nop 0
    v_fma_mixlo_f16 v96, v0, |v64|, 0
    v_fma_mixlo_f16 v97, v1, |v65|, 0
    v_fma_mixlo_f16 v98, v2, |v66|, 0
    v_fma_mixlo_f16 v99, v3, |v67|, 0
    v_fma_mixhi_f16 v96, v16, -|v64|, 0
    v_fma_mixhi_f16 v97, v17, -|v65|, 0
    v_fma_mixhi_f16 v98, v18, -|v66|, 0
    v_fma_mixhi_f16 v99, v19, -|v67|, 0
    v_fma_mixlo_f16 v100, v4, |v68|, 0
    v_fma_mixlo_f16 v101, v5, |v69|, 0
    v_mfma_f32_32x32x16_f16 v[32:47], v[96:99], v[144:147], 0
    v_fma_mixlo_f16 v102, v6, |v70|, 0
    v_fma_mixlo_f16 v103, v7, |v71|, 0
    v_fma_mixhi_f16 v100, v20, -|v68|, 0
    v_fma_mixhi_f16 v101, v21, -|v69|, 0
    v_mfma_f32_32x32x16_f16 v[48:63], v[96:99], v[160:163], 0
    v_fma_mixhi_f16 v102, v22, -|v70|, 0
    v_fma_mixhi_f16 v103, v23, -|v71|, 0
    v_fma_mixlo_f16 v104, v8, |v72|, 0
    v_fma_mixlo_f16 v105, v9, |v73|, 0
    v_mfma_f32_32x32x16_f16 v[32:47], v[100:103], v[148:151], v[32:47]
    v_fma_mixlo_f16 v106, v10, |v74|, 0
    v_fma_mixlo_f16 v107, v11, |v75|, 0
    v_fma_mixhi_f16 v104, v24, -|v72|, 0
    v_fma_mixhi_f16 v105, v25, -|v73|, 0
    v_mfma_f32_32x32x16_f16 v[48:63], v[100:103], v[164:167], v[48:63]
    v_fma_mixhi_f16 v106, v26, -|v74|, 0
    v_fma_mixhi_f16 v107, v27, -|v75|, 0
    v_fma_mixlo_f16 v108, v12, |v76|, 0
    v_fma_mixlo_f16 v109, v13, |v77|, 0
    v_mfma_f32_32x32x16_f16 v[32:47], v[104:107], v[152:155], v[32:47]
    v_fma_mixlo_f16 v110, v14, |v78|, 0
    v_fma_mixlo_f16 v111, v15, |v79|, 0
    v_fma_mixhi_f16 v108, v28, -|v76|, 0
    v_fma_mixhi_f16 v109, v29, -|v77|, 0
    v_mfma_f32_32x32x16_f16 v[48:63], v[104:107], v[168:171], v[48:63]
    v_fma_mixhi_f16 v110, v30, -|v78|, 0
    v_fma_mixhi_f16 v111, v31, -|v79|, 0
    s_nop 1
    v_mfma_f32_32x32x16_f16 v[32:47], v[108:111], v[156:159], v[32:47]
    v_mfma_f32_32x32x16_f16 v[48:63], v[108:111], v[172:175], v[48:63]
    s_nop 11
    v_cvt_pk_f16_f32 v112, v32, v48
    v_cvt_pk_f16_f32 v113, v33, v49
    v_cvt_pk_f16_f32 v114, v34, v50
    v_cvt_pk_f16_f32 v115, v35, v51
    v_pk_mul_f16 v96, v112, v128 op_sel:[0,0] op_sel_hi:[1,0]
    v_pk_mul_f16 v97, v113, v129 op_sel:[0,0] op_sel_hi:[1,0]
    v_pk_mul_f16 v98, v114, v130 op_sel:[0,0] op_sel_hi:[1,0]
    v_pk_mul_f16 v99, v115, v131 op_sel:[0,0] op_sel_hi:[1,0]
    v_pk_fma_f16 v96, v112, v128, v96 op_sel:[1,1,0] op_sel_hi:[0,1,1] neg_lo:[1,0,0]
    v_pk_fma_f16 v97, v113, v129, v97 op_sel:[1,1,0] op_sel_hi:[0,1,1] neg_lo:[1,0,0]
    v_pk_fma_f16 v98, v114, v130, v98 op_sel:[1,1,0] op_sel_hi:[0,1,1] neg_lo:[1,0,0]
    v_pk_fma_f16 v99, v115, v131, v99 op_sel:[1,1,0] op_sel_hi:[0,1,1] neg_lo:[1,0,0]
    v_cvt_pk_f16_f32 v116, v36, v52
    v_cvt_pk_f16_f32 v117, v37, v53
    v_mfma_f32_32x32x16_f16 v[64:79], v[144:147], v[96:99], 0
    v_cvt_pk_f16_f32 v118, v38, v54
    v_cvt_pk_f16_f32 v119, v39, v55
    v_pk_mul_f16 v100, v116, v132 op_sel:[0,0] op_sel_hi:[1,0]
    v_pk_mul_f16 v101, v117, v133 op_sel:[0,0] op_sel_hi:[1,0]
    v_pk_mul_f16 v102, v118, v134 op_sel:[0,0] op_sel_hi:[1,0]
    v_pk_mul_f16 v103, v119, v135 op_sel:[0,0] op_sel_hi:[1,0]
    v_mfma_f32_32x32x16_f16 v[80:95], v[160:163], v[96:99], 0
    v_pk_fma_f16 v100, v116, v132, v100 op_sel:[1,1,0] op_sel_hi:[0,1,1] neg_lo:[1,0,0]
    v_pk_fma_f16 v101, v117, v133, v101 op_sel:[1,1,0] op_sel_hi:[0,1,1] neg_lo:[1,0,0]
    v_pk_fma_f16 v102, v118, v134, v102 op_sel:[1,1,0] op_sel_hi:[0,1,1] neg_lo:[1,0,0]
    v_pk_fma_f16 v103, v119, v135, v103 op_sel:[1,1,0] op_sel_hi:[0,1,1] neg_lo:[1,0,0]
    v_cvt_pk_f16_f32 v120, v40, v56
    v_cvt_pk_f16_f32 v121, v41, v57
    v_mfma_f32_32x32x16_f16 v[64:79], v[148:151], v[100:103], v[64:79]
    v_cvt_pk_f16_f32 v122, v42, v58
    v_cvt_pk_f16_f32 v123, v43, v59
    v_pk_mul_f16 v104, v120, v136 op_sel:[0,0] op_sel_hi:[1,0]
    v_pk_mul_f16 v105, v121, v137 op_sel:[0,0] op_sel_hi:[1,0]
    v_pk_mul_f16 v106, v122, v138 op_sel:[0,0] op_sel_hi:[1,0]
    v_pk_mul_f16 v107, v123, v139 op_sel:[0,0] op_sel_hi:[1,0]
    v_mfma_f32_32x32x16_f16 v[80:95], v[164:167], v[100:103], v[80:95]
    v_pk_fma_f16 v104, v120, v136, v104 op_sel:[1,1,0] op_sel_hi:[0,1,1] neg_lo:[1,0,0]
    v_pk_fma_f16 v105, v121, v137, v105 op_sel:[1,1,0] op_sel_hi:[0,1,1] neg_lo:[1,0,0]
    v_pk_fma_f16 v106, v122, v138, v106 op_sel:[1,1,0] op_sel_hi:[0,1,1] neg_lo:[1,0,0]
    v_pk_fma_f16 v107, v123, v139, v107 op_sel:[1,1,0] op_sel_hi:[0,1,1] neg_lo:[1,0,0]
    v_cvt_pk_f16_f32 v124, v44, v60
    v_cvt_pk_f16_f32 v125, v45, v61
    v_mfma_f32_32x32x16_f16 v[64:79], v[152:155], v[104:107], v[64:79]
    v_cvt_pk_f16_f32 v126, v46, v62
    v_cvt_pk_f16_f32 v127, v47, v63
    v_pk_mul_f16 v108, v124, v140 op_sel:[0,0] op_sel_hi:[1,0]
    v_pk_mul_f16 v109, v125, v141 op_sel:[0,0] op_sel_hi:[1,0]
    v_pk_mul_f16 v110, v126, v142 op_sel:[0,0] op_sel_hi:[1,0]
    v_pk_mul_f16 v111, v127, v143 op_sel:[0,0] op_sel_hi:[1,0]
    v_mfma_f32_32x32x16_f16 v[80:95], v[168:171], v[104:107], v[80:95]
    v_pk_fma_f16 v108, v124, v140, v108 op_sel:[1,1,0] op_sel_hi:[0,1,1] neg_lo:[1,0,0]
    v_pk_fma_f16 v109, v125, v141, v109 op_sel:[1,1,0] op_sel_hi:[0,1,1] neg_lo:[1,0,0]
    v_pk_fma_f16 v110, v126, v142, v110 op_sel:[1,1,0] op_sel_hi:[0,1,1] neg_lo:[1,0,0]
    v_pk_fma_f16 v111, v127, v143, v111 op_sel:[1,1,0] op_sel_hi:[0,1,1] neg_lo:[1,0,0]
    s_nop 1
    v_mfma_f32_32x32x16_f16 v[64:79], v[156:159], v[108:111], v[64:79]
    v_mfma_f32_32x32x16_f16 v[80:95], v[172:175], v[108:111], v[80:95]
    v_mov_b32 v253, s28
    v_mov_b32 v254, 3
    s_nop 9
    v_cvt_pk_f16_f32 v96, v64, v80
    v_cvt_pk_f16_f32 v97, v65, v81
    v_cvt_pk_f16_f32 v98, v66, v82
    v_cvt_pk_f16_f32 v99, v67, v83
    ds_write_b128 v245, v[96:99] offset:0
    v_cvt_pk_f16_f32 v100, v68, v84
    v_cvt_pk_f16_f32 v101, v69, v85
    v_cvt_pk_f16_f32 v102, v70, v86
    v_cvt_pk_f16_f32 v103, v71, v87
    ds_write_b128 v245, v[100:103] offset:1024
    v_cvt_pk_f16_f32 v104, v72, v88
    v_cvt_pk_f16_f32 v105, v73, v89
    v_cvt_pk_f16_f32 v106, v74, v90
    v_cvt_pk_f16_f32 v107, v75, v91
    ds_write_b128 v245, v[104:107] offset:2048
    v_cvt_pk_f16_f32 v108, v76, v92
    v_cvt_pk_f16_f32 v109, v77, v93
    v_cvt_pk_f16_f32 v110, v78, v94
    v_cvt_pk_f16_f32 v111, v79, v95
    ds_write_b128 v245, v[108:111] offset:3072
    ds_write_b32 v253, v254 offset:24608
    v_pk_mul_f16 v64, v96, v176 op_sel:[0,0] op_sel_hi:[1,0] neg_hi:[1,0]
    v_pk_mul_f16 v65, v97, v177 op_sel:[0,0] op_sel_hi:[1,0] neg_hi:[1,0]
    v_pk_mul_f16 v66, v98, v178 op_sel:[0,0] op_sel_hi:[1,0] neg_hi:[1,0]
    v_pk_mul_f16 v67, v99, v179 op_sel:[0,0] op_sel_hi:[1,0] neg_hi:[1,0]
    v_pk_mul_f16 v68, v100, v180 op_sel:[0,0] op_sel_hi:[1,0] neg_hi:[1,0]
    v_pk_mul_f16 v69, v101, v181 op_sel:[0,0] op_sel_hi:[1,0] neg_hi:[1,0]
    v_pk_mul_f16 v70, v102, v182 op_sel:[0,0] op_sel_hi:[1,0] neg_hi:[1,0]
    v_pk_mul_f16 v71, v103, v183 op_sel:[0,0] op_sel_hi:[1,0] neg_hi:[1,0]
    v_mov_b32_e64 v253, s29
    ds_read_b32 v254, v253 offset:24608
    ds_read_b128 v[112:115], v247 offset:0
    ds_read_b128 v[116:119], v247 offset:1024
    ds_read_b128 v[120:123], v247 offset:2048
    ds_read_b128 v[124:127], v247 offset:3072
    v_pk_mul_f16 v72, v104, v184 op_sel:[0,0] op_sel_hi:[1,0] neg_hi:[1,0]
    v_pk_mul_f16 v73, v105, v185 op_sel:[0,0] op_sel_hi:[1,0] neg_hi:[1,0]
    v_pk_mul_f16 v74, v106, v186 op_sel:[0,0] op_sel_hi:[1,0] neg_hi:[1,0]
    v_pk_mul_f16 v75, v107, v187 op_sel:[0,0] op_sel_hi:[1,0] neg_hi:[1,0]
    v_pk_mul_f16 v76, v108, v188 op_sel:[0,0] op_sel_hi:[1,0] neg_hi:[1,0]
    v_pk_mul_f16 v77, v109, v189 op_sel:[0,0] op_sel_hi:[1,0] neg_hi:[1,0]
    v_pk_mul_f16 v78, v110, v190 op_sel:[0,0] op_sel_hi:[1,0] neg_hi:[1,0]
    v_pk_mul_f16 v79, v111, v191 op_sel:[0,0] op_sel_hi:[1,0] neg_hi:[1,0]
    v_pk_fma_f16 v64, v96, v176, v64 op_sel:[1,1,0] op_sel_hi:[0,1,1] neg_lo:[1,0,0] neg_hi:[1,0,0]
    v_pk_fma_f16 v65, v97, v177, v65 op_sel:[1,1,0] op_sel_hi:[0,1,1] neg_lo:[1,0,0] neg_hi:[1,0,0]
    v_pk_fma_f16 v66, v98, v178, v66 op_sel:[1,1,0] op_sel_hi:[0,1,1] neg_lo:[1,0,0] neg_hi:[1,0,0]
    v_pk_fma_f16 v67, v99, v179, v67 op_sel:[1,1,0] op_sel_hi:[0,1,1] neg_lo:[1,0,0] neg_hi:[1,0,0]
    v_pk_fma_f16 v68, v100, v180, v68 op_sel:[1,1,0] op_sel_hi:[0,1,1] neg_lo:[1,0,0] neg_hi:[1,0,0]
    v_pk_fma_f16 v69, v101, v181, v69 op_sel:[1,1,0] op_sel_hi:[0,1,1] neg_lo:[1,0,0] neg_hi:[1,0,0]
    v_pk_fma_f16 v70, v102, v182, v70 op_sel:[1,1,0] op_sel_hi:[0,1,1] neg_lo:[1,0,0] neg_hi:[1,0,0]
    v_pk_fma_f16 v71, v103, v183, v71 op_sel:[1,1,0] op_sel_hi:[0,1,1] neg_lo:[1,0,0] neg_hi:[1,0,0]
    v_pk_fma_f16 v72, v104, v184, v72 op_sel:[1,1,0] op_sel_hi:[0,1,1] neg_lo:[1,0,0] neg_hi:[1,0,0]
    v_pk_fma_f16 v73, v105, v185, v73 op_sel:[1,1,0] op_sel_hi:[0,1,1] neg_lo:[1,0,0] neg_hi:[1,0,0]
    v_pk_fma_f16 v74, v106, v186, v74 op_sel:[1,1,0] op_sel_hi:[0,1,1] neg_lo:[1,0,0] neg_hi:[1,0,0]
    v_pk_fma_f16 v75, v107, v187, v75 op_sel:[1,1,0] op_sel_hi:[0,1,1] neg_lo:[1,0,0] neg_hi:[1,0,0]
    v_pk_fma_f16 v76, v108, v188, v76 op_sel:[1,1,0] op_sel_hi:[0,1,1] neg_lo:[1,0,0] neg_hi:[1,0,0]
    v_pk_fma_f16 v77, v109, v189, v77 op_sel:[1,1,0] op_sel_hi:[0,1,1] neg_lo:[1,0,0] neg_hi:[1,0,0]
    v_pk_fma_f16 v78, v110, v190, v78 op_sel:[1,1,0] op_sel_hi:[0,1,1] neg_lo:[1,0,0] neg_hi:[1,0,0]
    v_pk_fma_f16 v79, v111, v191, v79 op_sel:[1,1,0] op_sel_hi:[0,1,1] neg_lo:[1,0,0] neg_hi:[1,0,0]
    s_waitcnt lgkmcnt(4)
    v_readfirstlane_b32 s16, v254
    s_nop 0
    s_cmp_ge_u32 s16, 3
    s_nop 2
    s_cbranch_scc1 C_XOK_2
    s_mov_b32 s27, 0
LS_X2:
    s_nop 0
    ds_read_b32 v254, v253 offset:24608
    ds_read_b128 v[112:115], v247 offset:0
    ds_read_b128 v[116:119], v247 offset:1024
    ds_read_b128 v[120:123], v247 offset:2048
    ds_read_b128 v[124:127], v247 offset:3072
    s_add_u32 s27, s27, 1
    s_waitcnt lgkmcnt(4)
    v_readfirstlane_b32 s16, v254
    s_cmp_gt_u32 s27, 0xc3500
    s_nop 3
    s_cbranch_scc1 LSX_X2
    s_cmp_ge_u32 s16, 3
    s_cbranch_scc0 LS_X2
LSX_X2:
C_XOK_2:
    s_waitcnt lgkmcnt(3)
    v_pk_fma_f16 v64, v112, v192, v64 op_sel:[0,0,0] op_sel_hi:[1,0,1] neg_hi:[1,0,0]
    v_pk_fma_f16 v65, v113, v193, v65 op_sel:[0,0,0] op_sel_hi:[1,0,1] neg_hi:[1,0,0]
    v_pk_fma_f16 v66, v114, v194, v66 op_sel:[0,0,0] op_sel_hi:[1,0,1] neg_hi:[1,0,0]
    v_pk_fma_f16 v67, v115, v195, v67 op_sel:[0,0,0] op_sel_hi:[1,0,1] neg_hi:[1,0,0]
    v_pk_fma_f16 v64, v112, v192, v64 op_sel:[1,1,0] op_sel_hi:[0,1,1] neg_lo:[1,0,0] neg_hi:[1,0,0]
    v_pk_fma_f16 v65, v113, v193, v65 op_sel:[1,1,0] op_sel_hi:[0,1,1] neg_lo:[1,0,0] neg_hi:[1,0,0]
    v_pk_fma_f16 v66, v114, v194, v66 op_sel:[1,1,0] op_sel_hi:[0,1,1] neg_lo:[1,0,0] neg_hi:[1,0,0]
    v_pk_fma_f16 v67, v115, v195, v67 op_sel:[1,1,0] op_sel_hi:[0,1,1] neg_lo:[1,0,0] neg_hi:[1,0,0]
    s_waitcnt lgkmcnt(2)
    s_nop 0
    v_pk_fma_f16 v68, v116, v196, v68 op_sel:[0,0,0] op_sel_hi:[1,0,1] neg_hi:[1,0,0]
    v_mfma_f32_32x32x16_f16 v[32:47], v[64:67], v[144:147], 0
    v_pk_fma_f16 v69, v117, v197, v69 op_sel:[0,0,0] op_sel_hi:[1,0,1] neg_hi:[1,0,0]
    v_pk_fma_f16 v70, v118, v198, v70 op_sel:[0,0,0] op_sel_hi:[1,0,1] neg_hi:[1,0,0]
    v_pk_fma_f16 v71, v119, v199, v71 op_sel:[0,0,0] op_sel_hi:[1,0,1] neg_hi:[1,0,0]
    v_pk_fma_f16 v68, v116, v196, v68 op_sel:[1,1,0] op_sel_hi:[0,1,1] neg_lo:[1,0,0] neg_hi:[1,0,0]
    v_mfma_f32_32x32x16_f16 v[48:63], v[64:67], v[160:163], 0
    v_pk_fma_f16 v69, v117, v197, v69 op_sel:[1,1,0] op_sel_hi:[0,1,1] neg_lo:[1,0,0] neg_hi:[1,0,0]
    v_pk_fma_f16 v70, v118, v198, v70 op_sel:[1,1,0] op_sel_hi:[0,1,1] neg_lo:[1,0,0] neg_hi:[1,0,0]
    v_pk_fma_f16 v71, v119, v199, v71 op_sel:[1,1,0] op_sel_hi:[0,1,1] neg_lo:[1,0,0] neg_hi:[1,0,0]
    s_waitcnt lgkmcnt(1)
    s_nop 0
    v_pk_fma_f16 v72, v120, v200, v72 op_sel:[0,0,0] op_sel_hi:[1,0,1] neg_hi:[1,0,0]
    v_mfma_f32_32x32x16_f16 v[32:47], v[68:71], v[148:151], v[32:47]
    v_pk_fma_f16 v73, v121, v201, v73 op_sel:[0,0,0] op_sel_hi:[1,0,1] neg_hi:[1,0,0]
    v_pk_fma_f16 v74, v122, v202, v74 op_sel:[0,0,0] op_sel_hi:[1,0,1] neg_hi:[1,0,0]
    v_pk_fma_f16 v75, v123, v203, v75 op_sel:[0,0,0] op_sel_hi:[1,0,1] neg_hi:[1,0,0]
    v_pk_fma_f16 v72, v120, v200, v72 op_sel:[1,1,0] op_sel_hi:[0,1,1] neg_lo:[1,0,0] neg_hi:[1,0,0]
    v_mfma_f32_32x32x16_f16 v[48:63], v[68:71], v[164:167], v[48:63]
    v_pk_fma_f16 v73, v121, v201, v73 op_sel:[1,1,0] op_sel_hi:[0,1,1] neg_lo:[1,0,0] neg_hi:[1,0,0]
    v_pk_fma_f16 v74, v122, v202, v74 op_sel:[1,1,0] op_sel_hi:[0,1,1] neg_lo:[1,0,0] neg_hi:[1,0,0]
    v_pk_fma_f16 v75, v123, v203, v75 op_sel:[1,1,0] op_sel_hi:[0,1,1] neg_lo:[1,0,0] neg_hi:[1,0,0]
    s_waitcnt lgkmcnt(0)
    s_nop 0
    v_pk_fma_f16 v76, v124, v204, v76 op_sel:[0,0,0] op_sel_hi:[1,0,1] neg_hi:[1,0,0]
    v_mfma_f32_32x32x16_f16 v[32:47], v[72:75], v[152:155], v[32:47]
    v_pk_fma_f16 v77, v125, v205, v77 op_sel:[0,0,0] op_sel_hi:[1,0,1] neg_hi:[1,0,0]
    v_pk_fma_f16 v78, v126, v206, v78 op_sel:[0,0,0] op_sel_hi:[1,0,1] neg_hi:[1,0,0]
    v_pk_fma_f16 v79, v127, v207, v79 op_sel:[0,0,0] op_sel_hi:[1,0,1] neg_hi:[1,0,0]
    v_pk_fma_f16 v76, v124, v204, v76 op_sel:[1,1,0] op_sel_hi:[0,1,1] neg_lo:[1,0,0] neg_hi:[1,0,0]
    v_mfma_f32_32x32x16_f16 v[48:63], v[72:75], v[168:171], v[48:63]
    v_pk_fma_f16 v77, v125, v205, v77 op_sel:[1,1,0] op_sel_hi:[0,1,1] neg_lo:[1,0,0] neg_hi:[1,0,0]
    v_pk_fma_f16 v78, v126, v206, v78 op_sel:[1,1,0] op_sel_hi:[0,1,1] neg_lo:[1,0,0] neg_hi:[1,0,0]
    v_pk_fma_f16 v79, v127, v207, v79 op_sel:[1,1,0] op_sel_hi:[0,1,1] neg_lo:[1,0,0] neg_hi:[1,0,0]
    s_nop 1
    v_mfma_f32_32x32x16_f16 v[32:47], v[76:79], v[156:159], v[32:47]
    v_mfma_f32_32x32x16_f16 v[48:63], v[76:79], v[172:175], v[48:63]
    s_nop 11
    v_cvt_pk_f16_f32 v112, v32, v48
    v_cvt_pk_f16_f32 v113, v33, v49
    v_cvt_pk_f16_f32 v114, v34, v50
    v_cvt_pk_f16_f32 v115, v35, v51
    v_pk_mul_f16 v96, v112, v128 op_sel:[0,0] op_sel_hi:[1,0]
    v_pk_mul_f16 v97, v113, v129 op_sel:[0,0] op_sel_hi:[1,0]
    v_pk_mul_f16 v98, v114, v130 op_sel:[0,0] op_sel_hi:[1,0]
    v_pk_mul_f16 v99, v115, v131 op_sel:[0,0] op_sel_hi:[1,0]
    v_pk_fma_f16 v96, v112, v128, v96 op_sel:[1,1,0] op_sel_hi:[0,1,1] neg_lo:[1,0,0]
    v_pk_fma_f16 v97, v113, v129, v97 op_sel:[1,1,0] op_sel_hi:[0,1,1] neg_lo:[1,0,0]
    v_pk_fma_f16 v98, v114, v130, v98 op_sel:[1,1,0] op_sel_hi:[0,1,1] neg_lo:[1,0,0]
    v_pk_fma_f16 v99, v115, v131, v99 op_sel:[1,1,0] op_sel_hi:[0,1,1] neg_lo:[1,0,0]
    v_cvt_pk_f16_f32 v116, v36, v52
    v_cvt_pk_f16_f32 v117, v37, v53
    v_mfma_f32_32x32x16_f16 v[0:15], v[144:147], v[96:99], v[0:15]
    v_cvt_pk_f16_f32 v118, v38, v54
    v_cvt_pk_f16_f32 v119, v39, v55
    v_pk_mul_f16 v100, v116, v132 op_sel:[0,0] op_sel_hi:[1,0]
    v_pk_mul_f16 v101, v117, v133 op_sel:[0,0] op_sel_hi:[1,0]
    v_pk_mul_f16 v102, v118, v134 op_sel:[0,0] op_sel_hi:[1,0]
    v_pk_mul_f16 v103, v119, v135 op_sel:[0,0] op_sel_hi:[1,0]
    v_mfma_f32_32x32x16_f16 v[16:31], v[160:163], v[96:99], v[16:31]
    v_pk_fma_f16 v100, v116, v132, v100 op_sel:[1,1,0] op_sel_hi:[0,1,1] neg_lo:[1,0,0]
    v_pk_fma_f16 v101, v117, v133, v101 op_sel:[1,1,0] op_sel_hi:[0,1,1] neg_lo:[1,0,0]
    v_pk_fma_f16 v102, v118, v134, v102 op_sel:[1,1,0] op_sel_hi:[0,1,1] neg_lo:[1,0,0]
    v_pk_fma_f16 v103, v119, v135, v103 op_sel:[1,1,0] op_sel_hi:[0,1,1] neg_lo:[1,0,0]
    v_cvt_pk_f16_f32 v120, v40, v56
    v_cvt_pk_f16_f32 v121, v41, v57
    v_mfma_f32_32x32x16_f16 v[0:15], v[148:151], v[100:103], v[0:15]
    v_cvt_pk_f16_f32 v122, v42, v58
    v_cvt_pk_f16_f32 v123, v43, v59
    v_pk_mul_f16 v104, v120, v136 op_sel:[0,0] op_sel_hi:[1,0]
    v_pk_mul_f16 v105, v121, v137 op_sel:[0,0] op_sel_hi:[1,0]
    v_pk_mul_f16 v106, v122, v138 op_sel:[0,0] op_sel_hi:[1,0]
    v_pk_mul_f16 v107, v123, v139 op_sel:[0,0] op_sel_hi:[1,0]
    v_mfma_f32_32x32x16_f16 v[16:31], v[164:167], v[100:103], v[16:31]
    v_pk_fma_f16 v104, v120, v136, v104 op_sel:[1,1,0] op_sel_hi:[0,1,1] neg_lo:[1,0,0]
    v_pk_fma_f16 v105, v121, v137, v105 op_sel:[1,1,0] op_sel_hi:[0,1,1] neg_lo:[1,0,0]
    v_pk_fma_f16 v106, v122, v138, v106 op_sel:[1,1,0] op_sel_hi:[0,1,1] neg_lo:[1,0,0]
    v_pk_fma_f16 v107, v123, v139, v107 op_sel:[1,1,0] op_sel_hi:[0,1,1] neg_lo:[1,0,0]
    v_cvt_pk_f16_f32 v124, v44, v60
    v_cvt_pk_f16_f32 v125, v45, v61
    v_mfma_f32_32x32x16_f16 v[0:15], v[152:155], v[104:107], v[0:15]
    v_cvt_pk_f16_f32 v126, v46, v62
    v_cvt_pk_f16_f32 v127, v47, v63
    v_pk_mul_f16 v108, v124, v140 op_sel:[0,0] op_sel_hi:[1,0]
    v_pk_mul_f16 v109, v125, v141 op_sel:[0,0] op_sel_hi:[1,0]
    v_pk_mul_f16 v110, v126, v142 op_sel:[0,0] op_sel_hi:[1,0]
    v_pk_mul_f16 v111, v127, v143 op_sel:[0,0] op_sel_hi:[1,0]
    v_mfma_f32_32x32x16_f16 v[16:31], v[168:171], v[104:107], v[16:31]
    v_pk_fma_f16 v108, v124, v140, v108 op_sel:[1,1,0] op_sel_hi:[0,1,1] neg_lo:[1,0,0]
    v_pk_fma_f16 v109, v125, v141, v109 op_sel:[1,1,0] op_sel_hi:[0,1,1] neg_lo:[1,0,0]
    v_pk_fma_f16 v110, v126, v142, v110 op_sel:[1,1,0] op_sel_hi:[0,1,1] neg_lo:[1,0,0]
    v_pk_fma_f16 v111, v127, v143, v111 op_sel:[1,1,0] op_sel_hi:[0,1,1] neg_lo:[1,0,0]
    s_nop 1
    v_mfma_f32_32x32x16_f16 v[0:15], v[156:159], v[108:111], v[0:15]
    v_mfma_f32_32x32x16_f16 v[16:31], v[172:175], v[108:111], v[16:31]
    v_mov_b32 v253, s28
    v_mov_b32 v254, 3
    v_mov_b32 v80, s30
    v_mov_b32 v82, 1
    s_cmp_lg_u32 s14, 387
    s_nop 6
    s_cbranch_scc1 CC_REG_2
    v_mov_b32 v16, 0
    v_mov_b32 v17, 0
    v_mov_b32 v18, 0
    v_mov_b32 v19, 0
    v_mov_b32 v20, 0
    v_mov_b32 v21, 0
    v_mov_b32 v22, 0
    v_mov_b32 v23, 0
    v_mov_b32 v24, 0
    v_mov_b32 v25, 0
    v_mov_b32 v26, 0
    v_mov_b32 v27, 0
    v_mov_b32 v28, 0
    v_mov_b32 v29, 0
    v_mov_b32 v30, 0
    v_mov_b32_e64 v31, 0
    v_mul_f32 v48, 0x3f3504f3, v0
    v_mul_f32 v49, 0x3f3504f3, v1
    v_mul_f32 v50, 0x3f3504f3, v2
    v_mul_f32 v51, 0x3f3504f3, v3
    v_mul_f32 v52, 0x3f3504f3, v4
    v_mul_f32 v53, 0x3f3504f3, v5
    v_mul_f32 v54, 0x3f3504f3, v6
    v_mul_f32 v55, 0x3f3504f3, v7
    v_mul_f32 v56, 0x3f3504f3, v8
    v_mul_f32 v57, 0x3f3504f3, v9
    v_mul_f32 v58, 0x3f3504f3, v10
    v_mul_f32 v59, 0x3f3504f3, v11
    v_mul_f32 v60, 0x3f3504f3, v12
    v_mul_f32 v61, 0x3f3504f3, v13
    v_mul_f32 v62, 0x3f3504f3, v14
    v_mul_f32 v63, 0x3f3504f3, v15
    v_mul_f32 v32, v48, v48
    v_mul_f32 v33, v49, v49
    v_mul_f32 v34, v50, v50
    v_mul_f32 v35, v51, v51
    v_mul_f32 v36, v52, v52
    v_mul_f32 v37, v53, v53
    v_mul_f32 v38, v54, v54
    v_mul_f32 v39, v55, v55
    v_mul_f32 v40, v56, v56
    v_mul_f32 v41, v57, v57
    v_mul_f32 v42, v58, v58
    v_mul_f32 v43, v59, v59
    v_mul_f32 v44, v60, v60
    v_mul_f32 v45, v61, v61
    v_mul_f32 v46, v62, v62
    v_mul_f32 v47, v63, v63
    s_cmp_eq_u32 s13, 0
    s_nop 0
    s_cbranch_scc1 CC_S0_2
    s_branch CC_S1_2
CC_REG_2:
    s_cmp_eq_u32 s13, 0
    s_cbranch_scc0 CC_E1_2
    v_mul_f32 v40, v8, v8
    v_mul_f32 v41, v9, v9
    v_mul_f32 v42, v10, v10
    v_mul_f32 v43, v11, v11
    v_mul_f32 v44, v12, v12
    v_mul_f32 v45, v13, v13
    v_mul_f32 v46, v14, v14
    v_mul_f32 v47, v15, v15
    v_fmac_f32 v40, v24, v24
    v_fmac_f32 v41, v25, v25
    v_fmac_f32 v42, v26, v26
    v_fmac_f32 v43, v27, v27
    v_fmac_f32 v44, v28, v28
    v_fmac_f32 v45, v29, v29
    v_fmac_f32 v46, v30, v30
    v_fmac_f32 v47, v31, v31
    ds_write_b128 v248, v[40:43]
    ds_write_b128 v248, v[44:47] offset:1024
    ds_write_b32 v253, v254 offset:24624
    v_mul_f32 v32, v0, v0
    v_mul_f32 v33, v1, v1
    v_mul_f32 v34, v2, v2
    v_mul_f32 v35, v3, v3
    v_mul_f32 v36, v4, v4
    v_mul_f32 v37, v5, v5
    v_mul_f32 v38, v6, v6
    v_mul_f32 v39, v7, v7
    v_fmac_f32 v32, v16, v16
    v_fmac_f32 v33, v17, v17
    v_fmac_f32 v34, v18, v18
    v_fmac_f32 v35, v19, v19
    v_fmac_f32 v36, v20, v20
    v_fmac_f32 v37, v21, v21
    v_fmac_f32 v38, v22, v22
    v_fmac_f32 v39, v23, v23
    s_nop 1
    s_branch CC_R0_2
CC_S0_2:
    ds_write_b128 v248, v[40:43]
    ds_write_b128 v248, v[44:47] offset:1024
    ds_write_b32 v253, v254 offset:24624
CC_R0_2:
    s_mov_b32 s27, 0
LS_EN0_2:
    s_nop 0
    ds_read_b32 v81, v80 offset:24624
    ds_read_b128 v[48:51], v249
    ds_read_b128 v[52:55], v249 offset:1024
    s_add_u32 s27, s27, 1
    s_waitcnt lgkmcnt(2)
    v_readfirstlane_b32 s16, v81
    s_cmp_gt_u32 s27, 0xc3500
    s_nop 3
    s_cbranch_scc1 LSX_EN0_2
    s_cmp_ge_u32 s16, 3
    s_cbranch_scc0 LS_EN0_2
LSX_EN0_2:
    s_waitcnt lgkmcnt(0)
    v_add_f32 v48, v48, v32
    v_add_f32 v49, v49, v33
    v_add_f32 v50, v50, v34
    v_add_f32 v51, v51, v35
    v_add_f32 v52, v52, v36
    v_add_f32 v53, v53, v37
    v_add_f32 v54, v54, v38
    v_add_f32 v55, v55, v39
    s_nop 1
    s_branch CC_E2_2
CC_E1_2:
    v_mul_f32 v32, v0, v0
    v_mul_f32 v33, v1, v1
    v_mul_f32 v34, v2, v2
    v_mul_f32 v35, v3, v3
    v_mul_f32 v36, v4, v4
    v_mul_f32 v37, v5, v5
    v_mul_f32 v38, v6, v6
    v_mul_f32 v39, v7, v7
    v_fmac_f32 v32, v16, v16
    v_fmac_f32 v33, v17, v17
    v_fmac_f32 v34, v18, v18
    v_fmac_f32 v35, v19, v19
    v_fmac_f32 v36, v20, v20
    v_fmac_f32 v37, v21, v21
    v_fmac_f32 v38, v22, v22
    v_fmac_f32 v39, v23, v23
    ds_write_b128 v248, v[32:35]
    ds_write_b128 v248, v[36:39] offset:1024
    ds_write_b32 v253, v254 offset:24624
    v_mul_f32 v40, v8, v8
    v_mul_f32 v41, v9, v9
    v_mul_f32 v42, v10, v10
    v_mul_f32 v43, v11, v11
    v_mul_f32 v44, v12, v12
    v_mul_f32 v45, v13, v13
    v_mul_f32 v46, v14, v14
    v_mul_f32 v47, v15, v15
    v_fmac_f32 v40, v24, v24
    v_fmac_f32 v41, v25, v25
    v_fmac_f32 v42, v26, v26
    v_fmac_f32 v43, v27, v27
    v_fmac_f32 v44, v28, v28
    v_fmac_f32 v45, v29, v29
    v_fmac_f32 v46, v30, v30
    v_fmac_f32 v47, v31, v31
    s_nop 1
    s_branch CC_R1_2
CC_S1_2:
    ds_write_b128 v248, v[32:35]
    ds_write_b128 v248, v[36:39] offset:1024
    ds_write_b32 v253, v254 offset:24624
CC_R1_2:
    s_mov_b32 s27, 0
LS_EN1_2:
    s_nop 0
    ds_read_b32 v81, v80 offset:24624
    ds_read_b128 v[48:51], v249
    ds_read_b128 v[52:55], v249 offset:1024
    s_add_u32 s27, s27, 1
    s_waitcnt lgkmcnt(2)
    v_readfirstlane_b32 s16, v81
    s_cmp_gt_u32 s27, 0xc3500
    s_nop 3
    s_cbranch_scc1 LSX_EN1_2
    s_cmp_ge_u32 s16, 3
    s_cbranch_scc0 LS_EN1_2
LSX_EN1_2:
    s_waitcnt lgkmcnt(0)
    v_add_f32 v48, v48, v40
    v_add_f32 v49, v49, v41
    v_add_f32 v50, v50, v42
    v_add_f32 v51, v51, v43
    v_add_f32 v52, v52, v44
    v_add_f32 v53, v53, v45
    v_add_f32 v54, v54, v46
    v_add_f32 v55, v55, v47
    s_nop 1
CC_E2_2:
    s_nop 0
    v_cvt_pk_bf16_f32 v56, v48, v49
    v_cvt_pk_bf16_f32 v57, v50, v51
    v_cvt_pk_bf16_f32 v58, v52, v53
    v_cvt_pk_bf16_f32 v59, v54, v55
    v_or_b32 v56, 0x80008000, v56
    v_or_b32 v57, 0x80008000, v57
    v_or_b32 v58, 0x80008000, v58
    v_or_b32 v59, 0x80008000, v59
    buffer_store_dwordx4 v[56:59], v251, s[8:11], s44 offen sc1
    s_mov_b64 exec, 1
    ds_add_u32 v255, v82 offset:24596
    s_mov_b64 exec, -1
    s_add_u32 s44, s44, 0x100000
    v_add_u32_e64 v254, s31, v244
    ds_read_b128 v[176:179], v254 offset:0
    ds_read_b128 v[192:195], v254 offset:4096
    ds_read_b128 v[180:183], v254 offset:1024
    ds_read_b128 v[196:199], v254 offset:5120
    ds_read_b128 v[184:187], v254 offset:2048
    ds_read_b128 v[200:203], v254 offset:6144
    ds_read_b128 v[188:191], v254 offset:3072
    ds_read_b128 v[204:207], v254 offset:7168
    s_waitcnt lgkmcnt(0)
    v_mul_f32 v192, s25, v192
    v_mul_f32 v193, s25, v193
    v_mul_f32 v194, s25, v194
    v_mul_f32 v195, s25, v195
    v_mul_f32 v196, s25, v196
    v_mul_f32 v197, s25, v197
    v_mul_f32 v198, s25, v198
    v_mul_f32 v199, s25, v199
    v_mul_f32 v200, s25, v200
    v_mul_f32 v201, s25, v201
    v_mul_f32 v202, s25, v202
    v_mul_f32 v203, s25, v203
    v_mul_f32 v204, s25, v204
    v_mul_f32 v205, s25, v205
    v_mul_f32 v206, s25, v206
    v_mul_f32 v207, s25, v207
    s_mov_b32 s27, 0
    s_nop 0
LW_CH2:
    ds_read_b32 v253, v255 offset:24592
    s_add_u32 s27, s27, 1
    s_waitcnt lgkmcnt(0)
    v_readfirstlane_b32 s16, v253
    s_cmp_gt_u32 s27, 0xc3500
    s_nop 3
    s_cbranch_scc1 LWX_CH2
    s_cmp_ge_u32 s16, 3
    s_cbranch_scc1 LWX_CH2
    s_sleep 1
    s_branch LW_CH2
LWX_CH2:
    s_mov_b32 s27, 0
    s_sleep 12
C_POLL2_2:
    buffer_load_dwordx4 v[64:67], v252, s[8:11], s45 offen offset:0 sc1
    buffer_load_dwordx4 v[68:71], v252, s[8:11], s45 offen offset:16 sc1
    buffer_load_dwordx4 v[72:75], v252, s[8:11], s45 offen offset:2048 sc1
    buffer_load_dwordx4 v[76:79], v252, s[8:11], s45 offen offset:2064 sc1
    s_waitcnt vmcnt(0)
    s_nop 0
    v_bitop3_b32 v253, v64, v65, v66 bitop3:0x80
    v_bitop3_b32 v254, v67, v68, v69 bitop3:0x80
    v_bitop3_b32 v253, v253, v70, v71 bitop3:0x80
    v_bitop3_b32 v254, v254, v72, v73 bitop3:0x80
    v_bitop3_b32 v253, v253, v74, v75 bitop3:0x80
    v_bitop3_b32 v254, v254, v76, v77 bitop3:0x80
    v_bitop3_b32 v253, v253, v78, v79 bitop3:0x80
    v_and_b32 v253, v253, v254
    v_cmp_le_i32 vcc, 0, v253
    s_add_u32 s27, s27, 1
    s_cmp_gt_u32 s27, 20000
    s_nop 2
    s_cbranch_scc1 C_POLL2_2X
    s_cbranch_vccnz C_POLL2_2
C_POLL2_2X:
    s_add_u32 s45, s45, 0x10000
    v_mov_b32 v253, 1
    s_mov_b64 exec, 1
    ds_add_u32 v255, v253 offset:24668
    s_mov_b64 exec, -1
    s_nop 0
    v_fma_mixlo_f16 v96, v0, |v64|, 0
    v_fma_mixlo_f16 v97, v1, |v65|, 0
    v_fma_mixlo_f16 v98, v2, |v66|, 0
    v_fma_mixlo_f16 v99, v3, |v67|, 0
    v_fma_mixhi_f16 v96, v16, -|v64|, 0
    v_fma_mixhi_f16 v97, v17, -|v65|, 0
    v_fma_mixhi_f16 v98, v18, -|v66|, 0
    v_fma_mixhi_f16 v99, v19, -|v67|, 0
    v_fma_mixlo_f16 v100, v4, |v68|, 0
    v_fma_mixlo_f16 v101, v5, |v69|, 0
    v_mfma_f32_32x32x16_f16 v[32:47], v[96:99], v[144:147], 0
    v_fma_mixlo_f16 v102, v6, |v70|, 0
    v_fma_mixlo_f16 v103, v7, |v71|, 0
    v_fma_mixhi_f16 v100, v20, -|v68|, 0
    v_fma_mixhi_f16 v101, v21, -|v69|, 0
    v_mfma_f32_32x32x16_f16 v[48:63], v[96:99], v[160:163], 0
    v_fma_mixhi_f16 v102, v22, -|v70|, 0
    v_fma_mixhi_f16 v103, v23, -|v71|, 0
    v_fma_mixlo_f16 v104, v8, |v72|, 0
    v_fma_mixlo_f16 v105, v9, |v73|, 0
    v_mfma_f32_32x32x16_f16 v[32:47], v[100:103], v[148:151], v[32:47]
    v_fma_mixlo_f16 v106, v10, |v74|, 0
    v_fma_mixlo_f16 v107, v11, |v75|, 0
    v_fma_mixhi_f16 v104, v24, -|v72|, 0
    v_fma_mixhi_f16 v105, v25, -|v73|, 0
    v_mfma_f32_32x32x16_f16 v[48:63], v[100:103], v[164:167], v[48:63]
    v_fma_mixhi_f16 v106, v26, -|v74|, 0
    v_fma_mixhi_f16 v107, v27, -|v75|, 0
    v_fma_mixlo_f16 v108, v12, |v76|, 0
    v_fma_mixlo_f16 v109, v13, |v77|, 0
    v_mfma_f32_32x32x16_f16 v[32:47], v[104:107], v[152:155], v[32:47]
    v_fma_mixlo_f16 v110, v14, |v78|, 0
    v_fma_mixlo_f16 v111, v15, |v79|, 0
    v_fma_mixhi_f16 v108, v28, -|v76|, 0
    v_fma_mixhi_f16 v109, v29, -|v77|, 0
    v_mfma_f32_32x32x16_f16 v[48:63], v[104:107], v[168:171], v[48:63]
    v_fma_mixhi_f16 v110, v30, -|v78|, 0
    v_fma_mixhi_f16 v111, v31, -|v79|, 0
    s_nop 1
    v_mfma_f32_32x32x16_f16 v[32:47], v[108:111], v[156:159], v[32:47]
    v_mfma_f32_32x32x16_f16 v[48:63], v[108:111], v[172:175], v[48:63]
    s_nop 11
    v_cvt_pk_f16_f32 v112, v32, v48
    v_cvt_pk_f16_f32 v113, v33, v49
    v_cvt_pk_f16_f32 v114, v34, v50
    v_cvt_pk_f16_f32 v115, v35, v51
    v_pk_mul_f16 v96, v112, v128 op_sel:[0,0] op_sel_hi:[1,0]
    v_pk_mul_f16 v97, v113, v129 op_sel:[0,0] op_sel_hi:[1,0]
    v_pk_mul_f16 v98, v114, v130 op_sel:[0,0] op_sel_hi:[1,0]
    v_pk_mul_f16 v99, v115, v131 op_sel:[0,0] op_sel_hi:[1,0]
    v_pk_fma_f16 v96, v112, v128, v96 op_sel:[1,1,0] op_sel_hi:[0,1,1] neg_lo:[1,0,0]
    v_pk_fma_f16 v97, v113, v129, v97 op_sel:[1,1,0] op_sel_hi:[0,1,1] neg_lo:[1,0,0]
    v_pk_fma_f16 v98, v114, v130, v98 op_sel:[1,1,0] op_sel_hi:[0,1,1] neg_lo:[1,0,0]
    v_pk_fma_f16 v99, v115, v131, v99 op_sel:[1,1,0] op_sel_hi:[0,1,1] neg_lo:[1,0,0]
    v_cvt_pk_f16_f32 v116, v36, v52
    v_cvt_pk_f16_f32 v117, v37, v53
    v_mfma_f32_32x32x16_f16 v[64:79], v[144:147], v[96:99], 0
    v_cvt_pk_f16_f32 v118, v38, v54
    v_cvt_pk_f16_f32 v119, v39, v55
    v_pk_mul_f16 v100, v116, v132 op_sel:[0,0] op_sel_hi:[1,0]
    v_pk_mul_f16 v101, v117, v133 op_sel:[0,0] op_sel_hi:[1,0]
    v_pk_mul_f16 v102, v118, v134 op_sel:[0,0] op_sel_hi:[1,0]
    v_pk_mul_f16 v103, v119, v135 op_sel:[0,0] op_sel_hi:[1,0]
    v_mfma_f32_32x32x16_f16 v[80:95], v[160:163], v[96:99], 0
    v_pk_fma_f16 v100, v116, v132, v100 op_sel:[1,1,0] op_sel_hi:[0,1,1] neg_lo:[1,0,0]
    v_pk_fma_f16 v101, v117, v133, v101 op_sel:[1,1,0] op_sel_hi:[0,1,1] neg_lo:[1,0,0]
    v_pk_fma_f16 v102, v118, v134, v102 op_sel:[1,1,0] op_sel_hi:[0,1,1] neg_lo:[1,0,0]
    v_pk_fma_f16 v103, v119, v135, v103 op_sel:[1,1,0] op_sel_hi:[0,1,1] neg_lo:[1,0,0]
    v_cvt_pk_f16_f32 v120, v40, v56
    v_cvt_pk_f16_f32 v121, v41, v57
    v_mfma_f32_32x32x16_f16 v[64:79], v[148:151], v[100:103], v[64:79]
    v_cvt_pk_f16_f32 v122, v42, v58
    v_cvt_pk_f16_f32 v123, v43, v59
    v_pk_mul_f16 v104, v120, v136 op_sel:[0,0] op_sel_hi:[1,0]
    v_pk_mul_f16 v105, v121, v137 op_sel:[0,0] op_sel_hi:[1,0]
    v_pk_mul_f16 v106, v122, v138 op_sel:[0,0] op_sel_hi:[1,0]
    v_pk_mul_f16 v107, v123, v139 op_sel:[0,0] op_sel_hi:[1,0]
    v_mfma_f32_32x32x16_f16 v[80:95], v[164:167], v[100:103], v[80:95]
    v_pk_fma_f16 v104, v120, v136, v104 op_sel:[1,1,0] op_sel_hi:[0,1,1] neg_lo:[1,0,0]
    v_pk_fma_f16 v105, v121, v137, v105 op_sel:[1,1,0] op_sel_hi:[0,1,1] neg_lo:[1,0,0]
    v_pk_fma_f16 v106, v122, v138, v106 op_sel:[1,1,0] op_sel_hi:[0,1,1] neg_lo:[1,0,0]
    v_pk_fma_f16 v107, v123, v139, v107 op_sel:[1,1,0] op_sel_hi:[0,1,1] neg_lo:[1,0,0]
    v_cvt_pk_f16_f32 v124, v44, v60
    v_cvt_pk_f16_f32 v125, v45, v61
    v_mfma_f32_32x32x16_f16 v[64:79], v[152:155], v[104:107], v[64:79]
    v_cvt_pk_f16_f32 v126, v46, v62
    v_cvt_pk_f16_f32 v127, v47, v63
    v_pk_mul_f16 v108, v124, v140 op_sel:[0,0] op_sel_hi:[1,0]
    v_pk_mul_f16 v109, v125, v141 op_sel:[0,0] op_sel_hi:[1,0]
    v_pk_mul_f16 v110, v126, v142 op_sel:[0,0] op_sel_hi:[1,0]
    v_pk_mul_f16 v111, v127, v143 op_sel:[0,0] op_sel_hi:[1,0]
    v_mfma_f32_32x32x16_f16 v[80:95], v[168:171], v[104:107], v[80:95]
    v_pk_fma_f16 v108, v124, v140, v108 op_sel:[1,1,0] op_sel_hi:[0,1,1] neg_lo:[1,0,0]
    v_pk_fma_f16 v109, v125, v141, v109 op_sel:[1,1,0] op_sel_hi:[0,1,1] neg_lo:[1,0,0]
    v_pk_fma_f16 v110, v126, v142, v110 op_sel:[1,1,0] op_sel_hi:[0,1,1] neg_lo:[1,0,0]
    v_pk_fma_f16 v111, v127, v143, v111 op_sel:[1,1,0] op_sel_hi:[0,1,1] neg_lo:[1,0,0]
    s_nop 1
    v_mfma_f32_32x32x16_f16 v[64:79], v[156:159], v[108:111], v[64:79]
    v_mfma_f32_32x32x16_f16 v[80:95], v[172:175], v[108:111], v[80:95]
    v_mov_b32 v253, s28
    v_mov_b32 v254, 4
    s_nop 9
    v_cvt_pk_f16_f32 v96, v64, v80
    v_cvt_pk_f16_f32 v97, v65, v81
    v_cvt_pk_f16_f32 v98, v66, v82
    v_cvt_pk_f16_f32 v99, v67, v83
    ds_write_b128 v245, v[96:99] offset:0
    v_cvt_pk_f16_f32 v100, v68, v84
    v_cvt_pk_f16_f32 v101, v69, v85
    v_cvt_pk_f16_f32 v102, v70, v86
    v_cvt_pk_f16_f32 v103, v71, v87
    ds_write_b128 v245, v[100:103] offset:1024
    v_cvt_pk_f16_f32 v104, v72, v88
    v_cvt_pk_f16_f32 v105, v73, v89
    v_cvt_pk_f16_f32 v106, v74, v90
    v_cvt_pk_f16_f32 v107, v75, v91
    ds_write_b128 v245, v[104:107] offset:2048
    v_cvt_pk_f16_f32 v108, v76, v92
    v_cvt_pk_f16_f32 v109, v77, v93
    v_cvt_pk_f16_f32 v110, v78, v94
    v_cvt_pk_f16_f32 v111, v79, v95
    ds_write_b128 v245, v[108:111] offset:3072
    ds_write_b32 v253, v254 offset:24608
    v_pk_mul_f16 v64, v96, v208 op_sel:[0,0] op_sel_hi:[1,0] neg_hi:[1,0]
    v_pk_mul_f16 v65, v97, v209 op_sel:[0,0] op_sel_hi:[1,0] neg_hi:[1,0]
    v_pk_mul_f16 v66, v98, v210 op_sel:[0,0] op_sel_hi:[1,0] neg_hi:[1,0]
    v_pk_mul_f16 v67, v99, v211 op_sel:[0,0] op_sel_hi:[1,0] neg_hi:[1,0]
    v_pk_mul_f16 v68, v100, v212 op_sel:[0,0] op_sel_hi:[1,0] neg_hi:[1,0]
    v_pk_mul_f16 v69, v101, v213 op_sel:[0,0] op_sel_hi:[1,0] neg_hi:[1,0]
    v_pk_mul_f16 v70, v102, v214 op_sel:[0,0] op_sel_hi:[1,0] neg_hi:[1,0]
    v_pk_mul_f16 v71, v103, v215 op_sel:[0,0] op_sel_hi:[1,0] neg_hi:[1,0]
    v_mov_b32_e64 v253, s29
    ds_read_b32 v254, v253 offset:24608
    ds_read_b128 v[112:115], v247 offset:0
    ds_read_b128 v[116:119], v247 offset:1024
    ds_read_b128 v[120:123], v247 offset:2048
    ds_read_b128 v[124:127], v247 offset:3072
    v_pk_mul_f16 v72, v104, v216 op_sel:[0,0] op_sel_hi:[1,0] neg_hi:[1,0]
    v_pk_mul_f16 v73, v105, v217 op_sel:[0,0] op_sel_hi:[1,0] neg_hi:[1,0]
    v_pk_mul_f16 v74, v106, v218 op_sel:[0,0] op_sel_hi:[1,0] neg_hi:[1,0]
    v_pk_mul_f16 v75, v107, v219 op_sel:[0,0] op_sel_hi:[1,0] neg_hi:[1,0]
    v_pk_mul_f16 v76, v108, v220 op_sel:[0,0] op_sel_hi:[1,0] neg_hi:[1,0]
    v_pk_mul_f16 v77, v109, v221 op_sel:[0,0] op_sel_hi:[1,0] neg_hi:[1,0]
    v_pk_mul_f16 v78, v110, v222 op_sel:[0,0] op_sel_hi:[1,0] neg_hi:[1,0]
    v_pk_mul_f16 v79, v111, v223 op_sel:[0,0] op_sel_hi:[1,0] neg_hi:[1,0]
    v_pk_fma_f16 v64, v96, v208, v64 op_sel:[1,1,0] op_sel_hi:[0,1,1] neg_lo:[1,0,0] neg_hi:[1,0,0]
    v_pk_fma_f16 v65, v97, v209, v65 op_sel:[1,1,0] op_sel_hi:[0,1,1] neg_lo:[1,0,0] neg_hi:[1,0,0]
    v_pk_fma_f16 v66, v98, v210, v66 op_sel:[1,1,0] op_sel_hi:[0,1,1] neg_lo:[1,0,0] neg_hi:[1,0,0]
    v_pk_fma_f16 v67, v99, v211, v67 op_sel:[1,1,0] op_sel_hi:[0,1,1] neg_lo:[1,0,0] neg_hi:[1,0,0]
    v_pk_fma_f16 v68, v100, v212, v68 op_sel:[1,1,0] op_sel_hi:[0,1,1] neg_lo:[1,0,0] neg_hi:[1,0,0]
    v_pk_fma_f16 v69, v101, v213, v69 op_sel:[1,1,0] op_sel_hi:[0,1,1] neg_lo:[1,0,0] neg_hi:[1,0,0]
    v_pk_fma_f16 v70, v102, v214, v70 op_sel:[1,1,0] op_sel_hi:[0,1,1] neg_lo:[1,0,0] neg_hi:[1,0,0]
    v_pk_fma_f16 v71, v103, v215, v71 op_sel:[1,1,0] op_sel_hi:[0,1,1] neg_lo:[1,0,0] neg_hi:[1,0,0]
    v_pk_fma_f16 v72, v104, v216, v72 op_sel:[1,1,0] op_sel_hi:[0,1,1] neg_lo:[1,0,0] neg_hi:[1,0,0]
    v_pk_fma_f16 v73, v105, v217, v73 op_sel:[1,1,0] op_sel_hi:[0,1,1] neg_lo:[1,0,0] neg_hi:[1,0,0]
    v_pk_fma_f16 v74, v106, v218, v74 op_sel:[1,1,0] op_sel_hi:[0,1,1] neg_lo:[1,0,0] neg_hi:[1,0,0]
    v_pk_fma_f16 v75, v107, v219, v75 op_sel:[1,1,0] op_sel_hi:[0,1,1] neg_lo:[1,0,0] neg_hi:[1,0,0]
    v_pk_fma_f16 v76, v108, v220, v76 op_sel:[1,1,0] op_sel_hi:[0,1,1] neg_lo:[1,0,0] neg_hi:[1,0,0]
    v_pk_fma_f16 v77, v109, v221, v77 op_sel:[1,1,0] op_sel_hi:[0,1,1] neg_lo:[1,0,0] neg_hi:[1,0,0]
    v_pk_fma_f16 v78, v110, v222, v78 op_sel:[1,1,0] op_sel_hi:[0,1,1] neg_lo:[1,0,0] neg_hi:[1,0,0]
    v_pk_fma_f16 v79, v111, v223, v79 op_sel:[1,1,0] op_sel_hi:[0,1,1] neg_lo:[1,0,0] neg_hi:[1,0,0]
    s_waitcnt lgkmcnt(4)
    v_readfirstlane_b32 s16, v254
    s_nop 0
    s_cmp_ge_u32 s16, 4
    s_nop 2
    s_cbranch_scc1 C_XOK_3
    s_mov_b32 s27, 0
LS_X3:
    s_nop 0
    ds_read_b32 v254, v253 offset:24608
    ds_read_b128 v[112:115], v247 offset:0
    ds_read_b128 v[116:119], v247 offset:1024
    ds_read_b128 v[120:123], v247 offset:2048
    ds_read_b128 v[124:127], v247 offset:3072
    s_add_u32 s27, s27, 1
    s_waitcnt lgkmcnt(4)
    v_readfirstlane_b32 s16, v254
    s_cmp_gt_u32 s27, 0xc3500
    s_nop 3
    s_cbranch_scc1 LSX_X3
    s_cmp_ge_u32 s16, 4
    s_cbranch_scc0 LS_X3
LSX_X3:
C_XOK_3:
    s_waitcnt lgkmcnt(3)
    v_pk_fma_f16 v64, v112, v224, v64 op_sel:[0,0,0] op_sel_hi:[1,0,1] neg_hi:[1,0,0]
    v_pk_fma_f16 v65, v113, v225, v65 op_sel:[0,0,0] op_sel_hi:[1,0,1] neg_hi:[1,0,0]
    v_pk_fma_f16 v66, v114, v226, v66 op_sel:[0,0,0] op_sel_hi:[1,0,1] neg_hi:[1,0,0]
    v_pk_fma_f16 v67, v115, v227, v67 op_sel:[0,0,0] op_sel_hi:[1,0,1] neg_hi:[1,0,0]
    v_pk_fma_f16 v64, v112, v224, v64 op_sel:[1,1,0] op_sel_hi:[0,1,1] neg_lo:[1,0,0] neg_hi:[1,0,0]
    v_pk_fma_f16 v65, v113, v225, v65 op_sel:[1,1,0] op_sel_hi:[0,1,1] neg_lo:[1,0,0] neg_hi:[1,0,0]
    v_pk_fma_f16 v66, v114, v226, v66 op_sel:[1,1,0] op_sel_hi:[0,1,1] neg_lo:[1,0,0] neg_hi:[1,0,0]
    v_pk_fma_f16 v67, v115, v227, v67 op_sel:[1,1,0] op_sel_hi:[0,1,1] neg_lo:[1,0,0] neg_hi:[1,0,0]
    s_waitcnt lgkmcnt(2)
    s_nop 0
    v_pk_fma_f16 v68, v116, v228, v68 op_sel:[0,0,0] op_sel_hi:[1,0,1] neg_hi:[1,0,0]
    v_mfma_f32_32x32x16_f16 v[32:47], v[64:67], v[144:147], 0
    v_pk_fma_f16 v69, v117, v229, v69 op_sel:[0,0,0] op_sel_hi:[1,0,1] neg_hi:[1,0,0]
    v_pk_fma_f16 v70, v118, v230, v70 op_sel:[0,0,0] op_sel_hi:[1,0,1] neg_hi:[1,0,0]
    v_pk_fma_f16 v71, v119, v231, v71 op_sel:[0,0,0] op_sel_hi:[1,0,1] neg_hi:[1,0,0]
    v_pk_fma_f16 v68, v116, v228, v68 op_sel:[1,1,0] op_sel_hi:[0,1,1] neg_lo:[1,0,0] neg_hi:[1,0,0]
    v_mfma_f32_32x32x16_f16 v[48:63], v[64:67], v[160:163], 0
    v_pk_fma_f16 v69, v117, v229, v69 op_sel:[1,1,0] op_sel_hi:[0,1,1] neg_lo:[1,0,0] neg_hi:[1,0,0]
    v_pk_fma_f16 v70, v118, v230, v70 op_sel:[1,1,0] op_sel_hi:[0,1,1] neg_lo:[1,0,0] neg_hi:[1,0,0]
    v_pk_fma_f16 v71, v119, v231, v71 op_sel:[1,1,0] op_sel_hi:[0,1,1] neg_lo:[1,0,0] neg_hi:[1,0,0]
    s_waitcnt lgkmcnt(1)
    s_nop 0
    v_pk_fma_f16 v72, v120, v232, v72 op_sel:[0,0,0] op_sel_hi:[1,0,1] neg_hi:[1,0,0]
    v_mfma_f32_32x32x16_f16 v[32:47], v[68:71], v[148:151], v[32:47]
    v_pk_fma_f16 v73, v121, v233, v73 op_sel:[0,0,0] op_sel_hi:[1,0,1] neg_hi:[1,0,0]
    v_pk_fma_f16 v74, v122, v234, v74 op_sel:[0,0,0] op_sel_hi:[1,0,1] neg_hi:[1,0,0]
    v_pk_fma_f16 v75, v123, v235, v75 op_sel:[0,0,0] op_sel_hi:[1,0,1] neg_hi:[1,0,0]
    v_pk_fma_f16 v72, v120, v232, v72 op_sel:[1,1,0] op_sel_hi:[0,1,1] neg_lo:[1,0,0] neg_hi:[1,0,0]
    v_mfma_f32_32x32x16_f16 v[48:63], v[68:71], v[164:167], v[48:63]
    v_pk_fma_f16 v73, v121, v233, v73 op_sel:[1,1,0] op_sel_hi:[0,1,1] neg_lo:[1,0,0] neg_hi:[1,0,0]
    v_pk_fma_f16 v74, v122, v234, v74 op_sel:[1,1,0] op_sel_hi:[0,1,1] neg_lo:[1,0,0] neg_hi:[1,0,0]
    v_pk_fma_f16 v75, v123, v235, v75 op_sel:[1,1,0] op_sel_hi:[0,1,1] neg_lo:[1,0,0] neg_hi:[1,0,0]
    s_waitcnt lgkmcnt(0)
    s_nop 0
    v_pk_fma_f16 v76, v124, v236, v76 op_sel:[0,0,0] op_sel_hi:[1,0,1] neg_hi:[1,0,0]
    v_mfma_f32_32x32x16_f16 v[32:47], v[72:75], v[152:155], v[32:47]
    v_pk_fma_f16 v77, v125, v237, v77 op_sel:[0,0,0] op_sel_hi:[1,0,1] neg_hi:[1,0,0]
    v_pk_fma_f16 v78, v126, v238, v78 op_sel:[0,0,0] op_sel_hi:[1,0,1] neg_hi:[1,0,0]
    v_pk_fma_f16 v79, v127, v239, v79 op_sel:[0,0,0] op_sel_hi:[1,0,1] neg_hi:[1,0,0]
    v_pk_fma_f16 v76, v124, v236, v76 op_sel:[1,1,0] op_sel_hi:[0,1,1] neg_lo:[1,0,0] neg_hi:[1,0,0]
    v_mfma_f32_32x32x16_f16 v[48:63], v[72:75], v[168:171], v[48:63]
    v_pk_fma_f16 v77, v125, v237, v77 op_sel:[1,1,0] op_sel_hi:[0,1,1] neg_lo:[1,0,0] neg_hi:[1,0,0]
    v_pk_fma_f16 v78, v126, v238, v78 op_sel:[1,1,0] op_sel_hi:[0,1,1] neg_lo:[1,0,0] neg_hi:[1,0,0]
    v_pk_fma_f16 v79, v127, v239, v79 op_sel:[1,1,0] op_sel_hi:[0,1,1] neg_lo:[1,0,0] neg_hi:[1,0,0]
    s_nop 1
    v_mfma_f32_32x32x16_f16 v[32:47], v[76:79], v[156:159], v[32:47]
    v_mfma_f32_32x32x16_f16 v[48:63], v[76:79], v[172:175], v[48:63]
    s_nop 11
    v_cvt_pk_f16_f32 v112, v32, v48
    v_cvt_pk_f16_f32 v113, v33, v49
    v_cvt_pk_f16_f32 v114, v34, v50
    v_cvt_pk_f16_f32 v115, v35, v51
    v_pk_mul_f16 v96, v112, v128 op_sel:[0,0] op_sel_hi:[1,0]
    v_pk_mul_f16 v97, v113, v129 op_sel:[0,0] op_sel_hi:[1,0]
    v_pk_mul_f16 v98, v114, v130 op_sel:[0,0] op_sel_hi:[1,0]
    v_pk_mul_f16 v99, v115, v131 op_sel:[0,0] op_sel_hi:[1,0]
    v_pk_fma_f16 v96, v112, v128, v96 op_sel:[1,1,0] op_sel_hi:[0,1,1] neg_lo:[1,0,0]
    v_pk_fma_f16 v97, v113, v129, v97 op_sel:[1,1,0] op_sel_hi:[0,1,1] neg_lo:[1,0,0]
    v_pk_fma_f16 v98, v114, v130, v98 op_sel:[1,1,0] op_sel_hi:[0,1,1] neg_lo:[1,0,0]
    v_pk_fma_f16 v99, v115, v131, v99 op_sel:[1,1,0] op_sel_hi:[0,1,1] neg_lo:[1,0,0]
    v_cvt_pk_f16_f32 v116, v36, v52
    v_cvt_pk_f16_f32 v117, v37, v53
    v_mfma_f32_32x32x16_f16 v[0:15], v[144:147], v[96:99], v[0:15]
    v_cvt_pk_f16_f32 v118, v38, v54
    v_cvt_pk_f16_f32 v119, v39, v55
    v_pk_mul_f16 v100, v116, v132 op_sel:[0,0] op_sel_hi:[1,0]
    v_pk_mul_f16 v101, v117, v133 op_sel:[0,0] op_sel_hi:[1,0]
    v_pk_mul_f16 v102, v118, v134 op_sel:[0,0] op_sel_hi:[1,0]
    v_pk_mul_f16 v103, v119, v135 op_sel:[0,0] op_sel_hi:[1,0]
    v_mfma_f32_32x32x16_f16 v[16:31], v[160:163], v[96:99], v[16:31]
    v_pk_fma_f16 v100, v116, v132, v100 op_sel:[1,1,0] op_sel_hi:[0,1,1] neg_lo:[1,0,0]
    v_pk_fma_f16 v101, v117, v133, v101 op_sel:[1,1,0] op_sel_hi:[0,1,1] neg_lo:[1,0,0]
    v_pk_fma_f16 v102, v118, v134, v102 op_sel:[1,1,0] op_sel_hi:[0,1,1] neg_lo:[1,0,0]
    v_pk_fma_f16 v103, v119, v135, v103 op_sel:[1,1,0] op_sel_hi:[0,1,1] neg_lo:[1,0,0]
    v_cvt_pk_f16_f32 v120, v40, v56
    v_cvt_pk_f16_f32 v121, v41, v57
    v_mfma_f32_32x32x16_f16 v[0:15], v[148:151], v[100:103], v[0:15]
    v_cvt_pk_f16_f32 v122, v42, v58
    v_cvt_pk_f16_f32 v123, v43, v59
    v_pk_mul_f16 v104, v120, v136 op_sel:[0,0] op_sel_hi:[1,0]
    v_pk_mul_f16 v105, v121, v137 op_sel:[0,0] op_sel_hi:[1,0]
    v_pk_mul_f16 v106, v122, v138 op_sel:[0,0] op_sel_hi:[1,0]
    v_pk_mul_f16 v107, v123, v139 op_sel:[0,0] op_sel_hi:[1,0]
    v_mfma_f32_32x32x16_f16 v[16:31], v[164:167], v[100:103], v[16:31]
    v_pk_fma_f16 v104, v120, v136, v104 op_sel:[1,1,0] op_sel_hi:[0,1,1] neg_lo:[1,0,0]
    v_pk_fma_f16 v105, v121, v137, v105 op_sel:[1,1,0] op_sel_hi:[0,1,1] neg_lo:[1,0,0]
    v_pk_fma_f16 v106, v122, v138, v106 op_sel:[1,1,0] op_sel_hi:[0,1,1] neg_lo:[1,0,0]
    v_pk_fma_f16 v107, v123, v139, v107 op_sel:[1,1,0] op_sel_hi:[0,1,1] neg_lo:[1,0,0]
    v_cvt_pk_f16_f32 v124, v44, v60
    v_cvt_pk_f16_f32 v125, v45, v61
    v_mfma_f32_32x32x16_f16 v[0:15], v[152:155], v[104:107], v[0:15]
    v_cvt_pk_f16_f32 v126, v46, v62
    v_cvt_pk_f16_f32 v127, v47, v63
    v_pk_mul_f16 v108, v124, v140 op_sel:[0,0] op_sel_hi:[1,0]
    v_pk_mul_f16 v109, v125, v141 op_sel:[0,0] op_sel_hi:[1,0]
    v_pk_mul_f16 v110, v126, v142 op_sel:[0,0] op_sel_hi:[1,0]
    v_pk_mul_f16 v111, v127, v143 op_sel:[0,0] op_sel_hi:[1,0]
    v_mfma_f32_32x32x16_f16 v[16:31], v[168:171], v[104:107], v[16:31]
    v_pk_fma_f16 v108, v124, v140, v108 op_sel:[1,1,0] op_sel_hi:[0,1,1] neg_lo:[1,0,0]
    v_pk_fma_f16 v109, v125, v141, v109 op_sel:[1,1,0] op_sel_hi:[0,1,1] neg_lo:[1,0,0]
    v_pk_fma_f16 v110, v126, v142, v110 op_sel:[1,1,0] op_sel_hi:[0,1,1] neg_lo:[1,0,0]
    v_pk_fma_f16 v111, v127, v143, v111 op_sel:[1,1,0] op_sel_hi:[0,1,1] neg_lo:[1,0,0]
    s_nop 1
    v_mfma_f32_32x32x16_f16 v[0:15], v[156:159], v[108:111], v[0:15]
    v_mfma_f32_32x32x16_f16 v[16:31], v[172:175], v[108:111], v[16:31]
    v_lshrrev_b32 v253, 2, v241
    s_lshl_b32 s16, s12, 6
    v_add_u32 v253, s16, v253
    v_and_b32 v254, 48, v244
    v_lshl_add_u32 v253, v253, 15, v254
    s_lshl_b32 s16, s14, 6
    s_add_u32 s16, s16, 0xc00000
    s_mov_b32 s17, 0x3c003c00
    s_cmp_eq_u32 s14, 387
    s_cselect_b32 s17, 0x00003800, s17
    s_lshl_b32 s15, s33, 23
    v_mov_b32 v254, 1
    v_fma_mixlo_f16 v32, v176, -v192, v0 op_sel_hi:[1,0,0]
    v_fma_mixlo_f16 v33, v177, -v193, v1 op_sel_hi:[1,0,0]
    v_fma_mixlo_f16 v34, v178, -v194, v2 op_sel_hi:[1,0,0]
    v_fma_mixlo_f16 v35, v179, -v195, v3 op_sel_hi:[1,0,0]
    v_fma_mixhi_f16 v32, v176, v192, v16 op_sel:[1,0,0] op_sel_hi:[1,0,0]
    v_fma_mixhi_f16 v33, v177, v193, v17 op_sel:[1,0,0] op_sel_hi:[1,0,0]
    v_fma_mixhi_f16 v34, v178, v194, v18 op_sel:[1,0,0] op_sel_hi:[1,0,0]
    v_fma_mixhi_f16 v35, v179, v195, v19 op_sel:[1,0,0] op_sel_hi:[1,0,0]
    v_pk_mul_f16 v32, v32, s17
    v_pk_mul_f16 v33, v33, s17
    v_pk_mul_f16 v34, v34, s17
    v_pk_mul_f16 v35, v35, s17
    v_or_b32 v32, 1, v32
    v_or_b32 v33, 1, v33
    v_or_b32 v34, 1, v34
    v_or_b32 v35, 1, v35
    buffer_store_dwordx4 v[32:35], v253, s[8:11], s16 offen sc1
    s_add_u32 s16, s16, 0x80000
    v_fma_mixlo_f16 v36, v180, -v196, v4 op_sel_hi:[1,0,0]
    v_fma_mixlo_f16 v37, v181, -v197, v5 op_sel_hi:[1,0,0]
    v_fma_mixlo_f16 v38, v182, -v198, v6 op_sel_hi:[1,0,0]
    v_fma_mixlo_f16 v39, v183, -v199, v7 op_sel_hi:[1,0,0]
    v_fma_mixhi_f16 v36, v180, v196, v20 op_sel:[1,0,0] op_sel_hi:[1,0,0]
    v_fma_mixhi_f16 v37, v181, v197, v21 op_sel:[1,0,0] op_sel_hi:[1,0,0]
    v_fma_mixhi_f16 v38, v182, v198, v22 op_sel:[1,0,0] op_sel_hi:[1,0,0]
    v_fma_mixhi_f16 v39, v183, v199, v23 op_sel:[1,0,0] op_sel_hi:[1,0,0]
    v_pk_mul_f16 v36, v36, s17
    v_pk_mul_f16 v37, v37, s17
    v_pk_mul_f16 v38, v38, s17
    v_pk_mul_f16 v39, v39, s17
    v_or_b32 v36, 1, v36
    v_or_b32 v37, 1, v37
    v_or_b32 v38, 1, v38
    v_or_b32 v39, 1, v39
    buffer_store_dwordx4 v[36:39], v253, s[8:11], s16 offen sc1
    s_add_u32 s16, s16, 0x80000
    v_fma_mixlo_f16 v40, v184, -v200, v8 op_sel_hi:[1,0,0]
    v_fma_mixlo_f16 v41, v185, -v201, v9 op_sel_hi:[1,0,0]
    v_fma_mixlo_f16 v42, v186, -v202, v10 op_sel_hi:[1,0,0]
    v_fma_mixlo_f16 v43, v187, -v203, v11 op_sel_hi:[1,0,0]
    v_fma_mixhi_f16 v40, v184, v200, v24 op_sel:[1,0,0] op_sel_hi:[1,0,0]
    v_fma_mixhi_f16 v41, v185, v201, v25 op_sel:[1,0,0] op_sel_hi:[1,0,0]
    v_fma_mixhi_f16 v42, v186, v202, v26 op_sel:[1,0,0] op_sel_hi:[1,0,0]
    v_fma_mixhi_f16 v43, v187, v203, v27 op_sel:[1,0,0] op_sel_hi:[1,0,0]
    v_pk_mul_f16 v40, v40, s17
    v_pk_mul_f16 v41, v41, s17
    v_pk_mul_f16 v42, v42, s17
    v_pk_mul_f16 v43, v43, s17
    v_or_b32 v40, 1, v40
    v_or_b32 v41, 1, v41
    v_or_b32 v42, 1, v42
    v_or_b32 v43, 1, v43
    buffer_store_dwordx4 v[40:43], v253, s[8:11], s16 offen sc1
    s_add_u32 s16, s16, 0x80000
    v_fma_mixlo_f16 v44, v188, -v204, v12 op_sel_hi:[1,0,0]
    v_fma_mixlo_f16 v45, v189, -v205, v13 op_sel_hi:[1,0,0]
    v_fma_mixlo_f16 v46, v190, -v206, v14 op_sel_hi:[1,0,0]
    v_fma_mixlo_f16 v47, v191, -v207, v15 op_sel_hi:[1,0,0]
    v_fma_mixhi_f16 v44, v188, v204, v28 op_sel:[1,0,0] op_sel_hi:[1,0,0]
    v_fma_mixhi_f16 v45, v189, v205, v29 op_sel:[1,0,0] op_sel_hi:[1,0,0]
    v_fma_mixhi_f16 v46, v190, v206, v30 op_sel:[1,0,0] op_sel_hi:[1,0,0]
    v_fma_mixhi_f16 v47, v191, v207, v31 op_sel:[1,0,0] op_sel_hi:[1,0,0]
    v_pk_mul_f16 v44, v44, s17
    v_pk_mul_f16 v45, v45, s17
    v_pk_mul_f16 v46, v46, s17
    v_pk_mul_f16 v47, v47, s17
    v_or_b32 v44, 1, v44
    v_or_b32 v45, 1, v45
    v_or_b32 v46, 1, v46
    v_or_b32 v47, 1, v47
    buffer_store_dwordx4 v[44:47], v253, s[8:11], s16 offen sc1
    s_mov_b64 exec, 1
    ds_add_u32 v255, v254 offset:24604
    s_mov_b64 exec, -1
    s_branch L_FINAL
L_HELPER:
    v_mov_b32 v30, 1
    v_lshlrev_b32 v31, 6, v241
    v_and_b32 v0, 255, v240
    v_lshlrev_b32 v245, 4, v0
    s_lshl_b32 s16, s2, 12
    s_add_u32 s16, s16, 0x1000000
    s_add_u32 s24, s16, 0x100000
    s_lshl_b32 s25, s12, 16
    s_lshl_b32 s17, s2, 8
    s_add_u32 s25, s25, s17
    s_add_u32 s25, s25, 0x1300000
    s_cmp_eq_u32 s3, 7
    s_cbranch_scc1 L_CLR8
    s_mov_b64 exec, 0xffff
    buffer_store_dwordx4 v[236:239], v244, s[8:11], s25 offen sc1
    s_mov_b64 exec, -1
    s_nop 0
L_CLR8:
    buffer_store_dwordx4 v[236:239], v245, s[8:11], s16 offen sc1
    s_mov_b32 s14, 0x05040302
    s_bitcmp1_b32 s2, 0
    s_nop 0
    s_cselect_b32 s14, 0x07060504, s14
    v_lshl_add_u32 v231, v243, 2, s12
    v_mul_u32_u24 v231, 1216, v231
    v_and_b32 v4, 7, v241
    v_mul_u32_u24 v4, 144, v4
    v_add_u32 v231, v231, v4
    v_bfe_u32 v4, v241, 3, 2
    v_lshl_add_u32 v231, v4, 3, v231
    s_lshl_b32 s24, s12, 2
    v_mov_b32 v230, s24
    v_lshrrev_b32 v1, 2, v0
    v_and_b32 v2, 1, v0
    v_lshlrev_b32_e64 v247, 4, v1
    v_lshl_add_u32 v247, v2, 3, v247
    v_bfe_u32 v3, v0, 1, 1
    v_mul_u32_u24 v3, 12352, v3
    v_add_u32 v251, v247, v3
    v_lshlrev_b32 v252, 2, v1
    v_lshlrev_b32 v253, 4, v2
    v_lshrrev_b32 v4, 3, v0
    v_add_u32 v4, 31, v4
    v_and_b32 v4, 31, v4
    v_lshrrev_b32 v6, 2, v4
    v_mul_u32_u24 v248, 144, v6
    v_and_b32 v4, 3, v4
    v_lshl_add_u32 v248, v4, 5, v248
    v_bfe_u32 v4, v0, 1, 2
    v_lshl_add_u32 v248, v4, 3, v248
    v_mul_u32_u24 v4, 2432, v2
    v_add_u32 v248, v248, v4
    v_and_b32 v4, 48, v244
    v_lshl_add_u32 v249, v1, 15, v4
    v_lshlrev_b32 v7, 12, v241
    s_lshl_b32 s18, s2, 4
    s_add_u32 s18, s18, 0x1340000
    s_lshl_b32 s46, s2, 15
    s_add_u32 s46, s46, 0x400000
    s_and_b32 s47, s2, 7
    s_lshl_b32 s47, s47, 13
    s_add_u32 s47, s47, 0x1340000
    s_waitcnt lgkmcnt(0)
    s_add_u32 s35, s34, 1
    s_waitcnt vmcnt(13)
    v_perm_b32 v160, v161, v160, s14
    v_perm_b32 v161, v162, v161, s14
    v_perm_b32 v164, v165, v164, s14
    v_perm_b32 v165, v166, v165, s14
    v_lshlrev_b32 v224, 16, v160
    v_and_b32 v225, 0xffff0000, v160
    v_lshlrev_b32 v226, 16, v164
    v_and_b32 v227, 0xffff0000, v164
    v_add_f32 v100, v224, v226
    v_sub_f32 v102, v224, v226
    v_max_f32 v228, |v100|, |v102|
    v_add_f32 v104, v225, v227
    v_sub_f32 v106, v225, v227
    v_max3_f32 v228, |v104|, |v106|, v228
    v_lshlrev_b32 v224, 16, v161
    v_and_b32 v225, 0xffff0000, v161
    v_lshlrev_b32 v226, 16, v165
    v_and_b32 v227, 0xffff0000, v165
    v_add_f32 v108, v224, v226
    v_sub_f32 v110, v224, v226
    v_max3_f32 v228, |v108|, |v110|, v228
    v_add_f32 v112, v225, v227
    v_sub_f32 v114, v225, v227
    v_max3_f32 v228, |v112|, |v114|, v228
    v_perm_b32 v168, v169, v168, s14
    v_perm_b32 v169, v170, v169, s14
    v_perm_b32 v172, v173, v172, s14
    v_perm_b32 v173, v174, v173, s14
    v_lshlrev_b32 v224, 16, v168
    v_and_b32 v225, 0xffff0000, v168
    v_lshlrev_b32 v226, 16, v172
    v_and_b32 v227, 0xffff0000, v172
    v_add_f32 v101, v224, v226
    v_sub_f32 v103, v224, v226
    v_max3_f32 v228, |v101|, |v103|, v228
    v_add_f32 v105, v225, v227
    v_sub_f32 v107, v225, v227
    v_max3_f32 v228, |v105|, |v107|, v228
    v_lshlrev_b32 v224, 16, v169
    v_and_b32 v225, 0xffff0000, v169
    v_lshlrev_b32 v226, 16, v173
    v_and_b32 v227, 0xffff0000, v173
    v_add_f32 v109, v224, v226
    v_sub_f32 v111, v224, v226
    v_max3_f32 v228, |v109|, |v111|, v228
    v_add_f32 v113, v225, v227
    v_sub_f32 v115, v225, v227
    v_max3_f32 v228, |v113|, |v115|, v228
    s_nop 1
    v_max_f32_dpp v228, v228, v228 quad_perm:[1,0,3,2] row_mask:0xf bank_mask:0xf
    s_nop 1
    v_max_f32_dpp v228, v228, v228 quad_perm:[2,3,0,1] row_mask:0xf bank_mask:0xf
    s_nop 1
    v_max_f32_dpp v228, v228, v228 row_half_mirror row_mask:0xf bank_mask:0xf
    s_nop 1
    v_max_f32_dpp v228, v228, v228 row_mirror row_mask:0xf bank_mask:0xf
    v_mov_b32 v229, v228
    s_nop 1
    v_permlane16_swap_b32 v228, v229
    v_max_f32 v228, v228, v229
    v_mov_b32 v229, v228
    s_nop 1
    v_permlane32_swap_b32 v228, v229
    v_max_f32 v228, v228, v229
    v_lshrrev_b32 v228, 23, v228
    v_add_u32 v228, 2, v228
    v_max_u32 v228, 0x61, v228
    v_min_u32 v228, 0xdc, v228
    v_sub_u32 v229, 0xfe, v228
    v_lshlrev_b32_e64 v229, 23, v229
    ds_write_b32 v230, v228 offset:24736
    v_fma_mixlo_f16 v116, v100, v229, 0
    v_fma_mixlo_f16 v117, v102, v229, 0
    v_fma_mixhi_f16 v116, v101, v229, 0
    v_fma_mixhi_f16 v117, v103, v229, 0
    v_fma_mixlo_f16 v118, v104, v229, 0
    v_fma_mixlo_f16 v119, v106, v229, 0
    v_fma_mixhi_f16 v118, v105, v229, 0
    v_fma_mixhi_f16 v119, v107, v229, 0
    v_fma_mixlo_f16 v120, v108, v229, 0
    v_fma_mixlo_f16 v121, v110, v229, 0
    v_fma_mixhi_f16 v120, v109, v229, 0
    v_fma_mixhi_f16 v121, v111, v229, 0
    v_fma_mixlo_f16 v122, v112, v229, 0
    v_fma_mixlo_f16 v123, v114, v229, 0
    v_fma_mixhi_f16 v122, v113, v229, 0
    v_fma_mixhi_f16 v123, v115, v229, 0
    ds_write_b64 v231, v[116:117] offset:44288
    ds_write_b64 v231, v[118:119] offset:44320
    ds_write_b64 v231, v[120:121] offset:44352
    ds_write_b64 v231, v[122:123] offset:44384
    s_waitcnt vmcnt(9)
    s_nop 0
    v_perm_b32 v176, v177, v176, s14
    v_perm_b32 v177, v178, v177, s14
    v_perm_b32 v180, v181, v180, s14
    v_perm_b32 v181, v182, v181, s14
    v_lshlrev_b32 v224, 16, v176
    v_and_b32 v225, 0xffff0000, v176
    v_lshlrev_b32 v226, 16, v180
    v_and_b32 v227, 0xffff0000, v180
    v_add_f32 v100, v224, v226
    v_sub_f32 v102, v224, v226
    v_max_f32 v228, |v100|, |v102|
    v_add_f32 v104, v225, v227
    v_sub_f32 v106, v225, v227
    v_max3_f32 v228, |v104|, |v106|, v228
    v_lshlrev_b32 v224, 16, v177
    v_and_b32 v225, 0xffff0000, v177
    v_lshlrev_b32 v226, 16, v181
    v_and_b32 v227, 0xffff0000, v181
    v_add_f32 v108, v224, v226
    v_sub_f32 v110, v224, v226
    v_max3_f32 v228, |v108|, |v110|, v228
    v_add_f32 v112, v225, v227
    v_sub_f32 v114, v225, v227
    v_max3_f32 v228, |v112|, |v114|, v228
    v_perm_b32 v184, v185, v184, s14
    v_perm_b32 v185, v186, v185, s14
    v_perm_b32 v188, v189, v188, s14
    v_perm_b32 v189, v190, v189, s14
    v_lshlrev_b32 v224, 16, v184
    v_and_b32 v225, 0xffff0000, v184
    v_lshlrev_b32 v226, 16, v188
    v_and_b32 v227, 0xffff0000, v188
    v_add_f32 v101, v224, v226
    v_sub_f32 v103, v224, v226
    v_max3_f32 v228, |v101|, |v103|, v228
    v_add_f32 v105, v225, v227
    v_sub_f32 v107, v225, v227
    v_max3_f32 v228, |v105|, |v107|, v228
    v_lshlrev_b32 v224, 16, v185
    v_and_b32 v225, 0xffff0000, v185
    v_lshlrev_b32 v226, 16, v189
    v_and_b32 v227, 0xffff0000, v189
    v_add_f32 v109, v224, v226
    v_sub_f32 v111, v224, v226
    v_max3_f32 v228, |v109|, |v111|, v228
    v_add_f32 v113, v225, v227
    v_sub_f32 v115, v225, v227
    v_max3_f32 v228, |v113|, |v115|, v228
    s_nop 1
    v_max_f32_dpp v228, v228, v228 quad_perm:[1,0,3,2] row_mask:0xf bank_mask:0xf
    s_nop 1
    v_max_f32_dpp v228, v228, v228 quad_perm:[2,3,0,1] row_mask:0xf bank_mask:0xf
    s_nop 1
    v_max_f32_dpp v228, v228, v228 row_half_mirror row_mask:0xf bank_mask:0xf
    s_nop 1
    v_max_f32_dpp v228, v228, v228 row_mirror row_mask:0xf bank_mask:0xf
    v_mov_b32 v229, v228
    s_nop 1
    v_permlane16_swap_b32 v228, v229
    v_max_f32 v228, v228, v229
    v_mov_b32 v229, v228
    s_nop 1
    v_permlane32_swap_b32 v228, v229
    v_max_f32 v228, v228, v229
    v_lshrrev_b32 v228, 23, v228
    v_add_u32 v228, 2, v228
    v_max_u32 v228, 0x61, v228
    v_min_u32 v228, 0xdc, v228
    v_sub_u32 v229, 0xfe, v228
    v_lshlrev_b32_e64 v229, 23, v229
    ds_write_b32 v230, v228 offset:24752
    v_fma_mixlo_f16 v116, v100, v229, 0
    v_fma_mixlo_f16 v117, v102, v229, 0
    v_fma_mixhi_f16 v116, v101, v229, 0
    v_fma_mixhi_f16 v117, v103, v229, 0
    v_fma_mixlo_f16 v118, v104, v229, 0
    v_fma_mixlo_f16 v119, v106, v229, 0
    v_fma_mixhi_f16 v118, v105, v229, 0
    v_fma_mixhi_f16 v119, v107, v229, 0
    v_fma_mixlo_f16 v120, v108, v229, 0
    v_fma_mixlo_f16 v121, v110, v229, 0
    v_fma_mixhi_f16 v120, v109, v229, 0
    v_fma_mixhi_f16 v121, v111, v229, 0
    v_fma_mixlo_f16 v122, v112, v229, 0
    v_fma_mixlo_f16 v123, v114, v229, 0
    v_fma_mixhi_f16 v122, v113, v229, 0
    v_fma_mixhi_f16 v123, v115, v229, 0
    ds_write_b64 v231, v[116:117] offset:54016
    ds_write_b64 v231, v[118:119] offset:54048
    ds_write_b64 v231, v[120:121] offset:54080
    ds_write_b64 v231, v[122:123] offset:54112
    s_mov_b64 exec, 1
    ds_add_u32 v255, v30 offset:24648
    s_mov_b64 exec, -1
    s_add_u32 s17, s19, 0x400000
    s_mov_b32 s27, 0
LS_WS0:
    s_nop 0
    ds_read_b32 v4, v255 offset:24648
    ds_read_b64 v[140:141], v248 offset:44288
    ds_read_b64 v[142:143], v248 offset:45504
    ds_read_b64 v[144:145], v248 offset:49152
    ds_read_b64 v[146:147], v248 offset:50368
    ds_read_b64 v[148:149], v248 offset:54016
    ds_read_b64 v[150:151], v248 offset:55232
    ds_read_b64 v[152:153], v248 offset:58880
    ds_read_b64 v[154:155], v248 offset:60096
    s_add_u32 s27, s27, 1
    s_waitcnt lgkmcnt(8)
    v_readfirstlane_b32 s16, v4
    s_cmp_gt_u32 s27, 0xc3500
    s_nop 3
    s_cbranch_scc1 LSX_WS0
    s_cmp_ge_u32 s16, 4
    s_cbranch_scc0 LS_WS0
LSX_WS0:
    s_waitcnt lgkmcnt(6)
    s_add_u32 s16, s17, 0x0
    buffer_store_dwordx4 v[140:143], v249, s[8:11], s16 offen sc1
    s_waitcnt lgkmcnt(4)
    s_add_u32 s16, s17, 0x200000
    buffer_store_dwordx4 v[144:147], v249, s[8:11], s16 offen sc1
    s_waitcnt lgkmcnt(2)
    s_add_u32 s16, s17, 0x400000
    buffer_store_dwordx4 v[148:151], v249, s[8:11], s16 offen sc1
    s_waitcnt lgkmcnt(0)
    s_add_u32 s16, s17, 0x600000
    buffer_store_dwordx4 v[152:155], v249, s[8:11], s16 offen sc1
    s_waitcnt vmcnt(4)
    s_nop 0
    v_perm_b32 v192, v193, v192, s14
    v_perm_b32 v193, v194, v193, s14
    v_perm_b32 v196, v197, v196, s14
    v_perm_b32 v197, v198, v197, s14
    v_lshlrev_b32 v224, 16, v192
    v_and_b32 v225, 0xffff0000, v192
    v_lshlrev_b32 v226, 16, v196
    v_and_b32 v227, 0xffff0000, v196
    v_add_f32 v100, v224, v226
    v_sub_f32 v102, v224, v226
    v_max_f32 v228, |v100|, |v102|
    v_add_f32 v104, v225, v227
    v_sub_f32 v106, v225, v227
    v_max3_f32 v228, |v104|, |v106|, v228
    v_lshlrev_b32 v224, 16, v193
    v_and_b32 v225, 0xffff0000, v193
    v_lshlrev_b32 v226, 16, v197
    v_and_b32 v227, 0xffff0000, v197
    v_add_f32 v108, v224, v226
    v_sub_f32 v110, v224, v226
    v_max3_f32 v228, |v108|, |v110|, v228
    v_add_f32 v112, v225, v227
    v_sub_f32 v114, v225, v227
    v_max3_f32 v228, |v112|, |v114|, v228
    v_perm_b32 v200, v201, v200, s14
    v_perm_b32 v201, v202, v201, s14
    v_perm_b32 v204, v205, v204, s14
    v_perm_b32 v205, v206, v205, s14
    v_lshlrev_b32 v224, 16, v200
    v_and_b32 v225, 0xffff0000, v200
    v_lshlrev_b32 v226, 16, v204
    v_and_b32 v227, 0xffff0000, v204
    v_add_f32 v101, v224, v226
    v_sub_f32 v103, v224, v226
    v_max3_f32 v228, |v101|, |v103|, v228
    v_add_f32 v105, v225, v227
    v_sub_f32 v107, v225, v227
    v_max3_f32 v228, |v105|, |v107|, v228
    v_lshlrev_b32 v224, 16, v201
    v_and_b32 v225, 0xffff0000, v201
    v_lshlrev_b32 v226, 16, v205
    v_and_b32 v227, 0xffff0000, v205
    v_add_f32 v109, v224, v226
    v_sub_f32 v111, v224, v226
    v_max3_f32 v228, |v109|, |v111|, v228
    v_add_f32 v113, v225, v227
    v_sub_f32 v115, v225, v227
    v_max3_f32 v228, |v113|, |v115|, v228
    s_nop 1
    v_max_f32_dpp v228, v228, v228 quad_perm:[1,0,3,2] row_mask:0xf bank_mask:0xf
    s_nop 1
    v_max_f32_dpp v228, v228, v228 quad_perm:[2,3,0,1] row_mask:0xf bank_mask:0xf
    s_nop 1
    v_max_f32_dpp v228, v228, v228 row_half_mirror row_mask:0xf bank_mask:0xf
    s_nop 1
    v_max_f32_dpp v228, v228, v228 row_mirror row_mask:0xf bank_mask:0xf
    v_mov_b32 v229, v228
    s_nop 1
    v_permlane16_swap_b32 v228, v229
    v_max_f32 v228, v228, v229
    v_mov_b32 v229, v228
    s_nop 1
    v_permlane32_swap_b32 v228, v229
    v_max_f32 v228, v228, v229
    v_lshrrev_b32 v228, 23, v228
    v_add_u32 v228, 2, v228
    v_max_u32 v228, 0x61, v228
    v_min_u32 v228, 0xdc, v228
    v_sub_u32 v229, 0xfe, v228
    v_lshlrev_b32_e64 v229, 23, v229
    ds_write_b32 v230, v228 offset:24768
    v_fma_mixlo_f16 v116, v100, v229, 0
    v_fma_mixlo_f16 v117, v102, v229, 0
    v_fma_mixhi_f16 v116, v101, v229, 0
    v_fma_mixhi_f16 v117, v103, v229, 0
    v_fma_mixlo_f16 v118, v104, v229, 0
    v_fma_mixlo_f16 v119, v106, v229, 0
    v_fma_mixhi_f16 v118, v105, v229, 0
    v_fma_mixhi_f16 v119, v107, v229, 0
    v_fma_mixlo_f16 v120, v108, v229, 0
    v_fma_mixlo_f16 v121, v110, v229, 0
    v_fma_mixhi_f16 v120, v109, v229, 0
    v_fma_mixhi_f16 v121, v111, v229, 0
    v_fma_mixlo_f16 v122, v112, v229, 0
    v_fma_mixlo_f16 v123, v114, v229, 0
    v_fma_mixhi_f16 v122, v113, v229, 0
    v_fma_mixhi_f16 v123, v115, v229, 0
    ds_write_b64 v231, v[116:117] offset:24832
    ds_write_b64 v231, v[118:119] offset:24864
    ds_write_b64 v231, v[120:121] offset:24896
    ds_write_b64 v231, v[122:123] offset:24928
    v_perm_b32 v208, v209, v208, s14
    v_perm_b32 v209, v210, v209, s14
    v_perm_b32 v212, v213, v212, s14
    v_perm_b32 v213, v214, v213, s14
    v_lshlrev_b32 v224, 16, v208
    v_and_b32 v225, 0xffff0000, v208
    v_lshlrev_b32 v226, 16, v212
    v_and_b32 v227, 0xffff0000, v212
    v_add_f32 v100, v224, v226
    v_sub_f32 v102, v224, v226
    v_max_f32 v228, |v100|, |v102|
    v_add_f32 v104, v225, v227
    v_sub_f32 v106, v225, v227
    v_max3_f32 v228, |v104|, |v106|, v228
    v_lshlrev_b32 v224, 16, v209
    v_and_b32 v225, 0xffff0000, v209
    v_lshlrev_b32 v226, 16, v213
    v_and_b32 v227, 0xffff0000, v213
    v_add_f32 v108, v224, v226
    v_sub_f32 v110, v224, v226
    v_max3_f32 v228, |v108|, |v110|, v228
    v_add_f32 v112, v225, v227
    v_sub_f32 v114, v225, v227
    v_max3_f32 v228, |v112|, |v114|, v228
    v_perm_b32 v216, v217, v216, s14
    v_perm_b32 v217, v218, v217, s14
    v_perm_b32 v220, v221, v220, s14
    v_perm_b32 v221, v222, v221, s14
    v_lshlrev_b32 v224, 16, v216
    v_and_b32 v225, 0xffff0000, v216
    v_lshlrev_b32 v226, 16, v220
    v_and_b32 v227, 0xffff0000, v220
    v_add_f32 v101, v224, v226
    v_sub_f32 v103, v224, v226
    v_max3_f32 v228, |v101|, |v103|, v228
    v_add_f32 v105, v225, v227
    v_sub_f32 v107, v225, v227
    v_max3_f32 v228, |v105|, |v107|, v228
    v_lshlrev_b32 v224, 16, v217
    v_and_b32 v225, 0xffff0000, v217
    v_lshlrev_b32 v226, 16, v221
    v_and_b32 v227, 0xffff0000, v221
    v_add_f32 v109, v224, v226
    v_sub_f32 v111, v224, v226
    v_max3_f32 v228, |v109|, |v111|, v228
    v_add_f32 v113, v225, v227
    v_sub_f32 v115, v225, v227
    v_max3_f32 v228, |v113|, |v115|, v228
    s_nop 1
    v_max_f32_dpp v228, v228, v228 quad_perm:[1,0,3,2] row_mask:0xf bank_mask:0xf
    s_nop 1
    v_max_f32_dpp v228, v228, v228 quad_perm:[2,3,0,1] row_mask:0xf bank_mask:0xf
    s_nop 1
    v_max_f32_dpp v228, v228, v228 row_half_mirror row_mask:0xf bank_mask:0xf
    s_nop 1
    v_max_f32_dpp v228, v228, v228 row_mirror row_mask:0xf bank_mask:0xf
    v_mov_b32 v229, v228
    s_nop 1
    v_permlane16_swap_b32 v228, v229
    v_max_f32 v228, v228, v229
    v_mov_b32 v229, v228
    s_nop 1
    v_permlane32_swap_b32 v228, v229
    v_max_f32 v228, v228, v229
    v_lshrrev_b32 v228, 23, v228
    v_add_u32 v228, 2, v228
    v_max_u32 v228, 0x61, v228
    v_min_u32 v228, 0xdc, v228
    v_sub_u32 v229, 0xfe, v228
    v_lshlrev_b32_e64 v229, 23, v229
    ds_write_b32 v230, v228 offset:24784
    v_fma_mixlo_f16 v116, v100, v229, 0
    v_fma_mixlo_f16 v117, v102, v229, 0
    v_fma_mixhi_f16 v116, v101, v229, 0
    v_fma_mixhi_f16 v117, v103, v229, 0
    v_fma_mixlo_f16 v118, v104, v229, 0
    v_fma_mixlo_f16 v119, v106, v229, 0
    v_fma_mixhi_f16 v118, v105, v229, 0
    v_fma_mixhi_f16 v119, v107, v229, 0
    v_fma_mixlo_f16 v120, v108, v229, 0
    v_fma_mixlo_f16 v121, v110, v229, 0
    v_fma_mixhi_f16 v120, v109, v229, 0
    v_fma_mixhi_f16 v121, v111, v229, 0
    v_fma_mixlo_f16 v122, v112, v229, 0
    v_fma_mixlo_f16 v123, v114, v229, 0
    v_fma_mixhi_f16 v122, v113, v229, 0
    v_fma_mixhi_f16 v123, v115, v229, 0
    ds_write_b64 v231, v[116:117] offset:34560
    ds_write_b64 v231, v[118:119] offset:34592
    ds_write_b64 v231, v[120:121] offset:34624
    ds_write_b64 v231, v[122:123] offset:34656
    s_waitcnt vmcnt(0)
    s_mov_b64 exec, 1
    ds_add_u32 v255, v30 offset:24652
    s_mov_b64 exec, -1
    s_mov_b64 exec, 1
    ds_add_rtn_u32 v32, v255, v30 offset:24644
    s_mov_b64 exec, -1
    v_and_b32 v33, 16, v244
    v_lshlrev_b32_e64 v34, 1, v33
    ds_read_b128 v[36:39], v33 offset:24704
    ds_read_b128 v[40:43], v34 offset:24736
    ds_read_b128 v[44:47], v34 offset:24752
    s_waitcnt lgkmcnt(3)
    v_readfirstlane_b32 s16, v32
    s_nop 0
    s_cmp_lg_u32 s16, 7
    s_nop 2
    s_cbranch_scc1 H_NOFN
    v_lshrrev_b32 v35, 1, v241
    v_lshl_add_u32 v33, v35, 13, v33
    v_lshlrev_b32 v34, 12, v241
    s_lshl_b32 s16, s2, 5
    s_add_u32 s16, s16, 0x1330000
    s_lshl_b32 s17, s2, 4
    s_add_u32 s17, s17, 0x1340000
    s_waitcnt lgkmcnt(0)
    v_cvt_pk_bf16_f32 v36, v36, v37
    v_cvt_pk_bf16_f32 v38, v38, v39
    v_mov_b32 v37, s35
    v_mov_b32_e64 v39, s35
    v_max3_u32 v35, v40, v41, v42
    v_max3_u32 v32, v43, v44, v45
    v_max3_u32 v35, v35, v46, v47
    v_max_u32 v35, v35, v32
    s_nop 1
    v_max_u32_dpp v35, v35, v35 quad_perm:[1,0,3,2] row_mask:0xf bank_mask:0xf
    v_and_b32 v32, 0xffffff00, v37
    v_lshl_or_b32 v40, v41, 8, v40
    v_lshl_or_b32 v40, v42, 16, v40
    v_lshl_or_b32 v40, v43, 24, v40
    v_lshl_or_b32 v44, v45, 8, v44
    v_lshl_or_b32 v44, v46, 16, v44
    v_lshl_or_b32 v44, v47, 24, v44
    v_mov_b32 v42, v44
    v_mov_b32 v41, s35
    v_or_b32_e64 v43, v32, v35
    s_mov_b64 exec, 0xffff
    buffer_store_dwordx4 v[40:43], v34, s[8:11], s17 offen sc1
    buffer_store_dwordx4 v[36:39], v33, s[8:11], s16 offen sc1
    s_mov_b64 exec, -1
    s_nop 0
H_NOFN:
    s_waitcnt lgkmcnt(0)
    s_mov_b32 s27, 0
LW_HR:
    ds_read_b32 v1, v255 offset:24640
    s_add_u32 s27, s27, 1
    s_waitcnt lgkmcnt(0)
    v_readfirstlane_b32 s16, v1
    s_cmp_gt_u32 s27, 0xc3500
    s_nop 3
    s_cbranch_scc1 LWX_HR
    s_cmp_ge_u32 s16, 4
    s_cbranch_scc1 LWX_HR
    s_sleep 1
    s_branch LW_HR
LWX_HR:
    s_nop 0
    ds_read_b64 v[16:17], v247 offset:20480
    ds_read_b64 v[18:19], v247 offset:21504
    ds_read_b64 v[20:21], v247 offset:22528
    ds_read_b64 v[22:23], v247 offset:23552
    s_setprio 2
    s_cmp_lg_u32 s3, 4
    s_cbranch_scc1 H_W0
    s_mov_b32 s27, 0
LW_HNA:
    ds_read_b32 v1, v255 offset:24644
    s_add_u32 s27, s27, 1
    s_waitcnt lgkmcnt(0)
    v_readfirstlane_b32 s16, v1
    s_cmp_gt_u32 s27, 0xc3500
    s_nop 3
    s_cbranch_scc1 LWX_HNA
    s_cmp_ge_u32 s16, 8
    s_cbranch_scc1 LWX_HNA
    s_sleep 1
    s_branch LW_HNA
LWX_HNA:
    s_sleep 24
    s_add_u32 s16, s47, 4096
    s_mov_b32 s27, 0
H_POLLW:
    s_nop 0
    buffer_load_dwordx4 v[160:163], v244, s[8:11], s47 offen offset:0 sc1
    buffer_load_dwordx4 v[164:167], v244, s[8:11], s47 offen offset:1024 sc1
    buffer_load_dwordx4 v[168:171], v244, s[8:11], s47 offen offset:2048 sc1
    buffer_load_dwordx4 v[172:175], v244, s[8:11], s47 offen offset:3072 sc1
    buffer_load_dwordx4 v[176:179], v244, s[8:11], s16 offen offset:0 sc1
    buffer_load_dwordx4 v[180:183], v244, s[8:11], s16 offen offset:1024 sc1
    buffer_load_dwordx4 v[184:187], v244, s[8:11], s16 offen offset:2048 sc1
    buffer_load_dwordx4 v[188:191], v244, s[8:11], s16 offen offset:3072 sc1
    s_waitcnt vmcnt(0)
    v_max3_u32 v192, v163, v167, v171
    v_max_u32 v192, v192, v175
    v_xor_b32 v161, s35, v161
    v_xor_b32 v163, s35, v163
    v_xor_b32 v165, s35, v165
    v_xor_b32 v167, s35, v167
    v_xor_b32 v169, s35, v169
    v_xor_b32 v171, s35, v171
    v_xor_b32 v173, s35, v173
    v_xor_b32 v175, s35, v175
    v_xor_b32 v177, s35, v177
    v_xor_b32 v179, s35, v179
    v_xor_b32 v181, s35, v181
    v_xor_b32 v183, s35, v183
    v_xor_b32 v185, s35, v185
    v_xor_b32 v187, s35, v187
    v_xor_b32 v189, s35, v189
    v_xor_b32 v191, s35, v191
    v_bitop3_b32 v2, v161, v165, v169 bitop3:0xfe
    v_bitop3_b32 v3, v173, v177, v181 bitop3:0xfe
    v_bitop3_b32 v2, v2, v185, v189 bitop3:0xfe
    v_or_b32_e64 v2, v2, v3
    v_bitop3_b32 v4, v163, v167, v171 bitop3:0xfe
    v_bitop3_b32 v3, v175, v179, v183 bitop3:0xfe
    v_bitop3_b32 v4, v4, v187, v191 bitop3:0xfe
    v_or_b32 v4, v4, v3
    v_lshrrev_b32 v4, 8, v4
    v_or_b32 v2, v2, v4
    v_cmp_ne_u32 vcc, 0, v2
    s_add_u32 s27, s27, 1
    s_cmp_gt_u32 s27, 20000
    s_nop 2
    s_cbranch_scc1 H_POLLWX
    s_cbranch_vccz H_POLLWX
    s_sleep 8
    s_branch H_POLLW
H_POLLWX:
    v_and_b32 v192, 0xff, v192
    s_cmp_ge_u32 s2, 128
    s_cselect_b64 vcc, -1, 0
    v_lshlrev_b32 v1, 2, v241
    v_max_u32_dpp v192, v192, v192 quad_perm:[1,0,3,2] row_mask:0xf bank_mask:0xf
    v_cndmask_b32 v161, v160, v162, vcc
    v_cndmask_b32 v165, v164, v166, vcc
    v_max_u32_dpp v192, v192, v192 quad_perm:[2,3,0,1] row_mask:0xf bank_mask:0xf
    v_cndmask_b32 v169, v168, v170, vcc
    v_cndmask_b32 v173, v172, v174, vcc
    v_max_u32_dpp v192, v192, v192 row_half_mirror row_mask:0xf bank_mask:0xf
    v_cndmask_b32 v177, v176, v178, vcc
    v_cndmask_b32 v181, v180, v182, vcc
    v_max_u32_dpp v192, v192, v192 row_mirror row_mask:0xf bank_mask:0xf
    v_cndmask_b32 v185, v184, v186, vcc
    v_cndmask_b32 v189, v188, v190, vcc
    v_mov_b32 v193, v192
    ds_write_b32 v1, v161 offset:12288
    ds_write_b32 v1, v165 offset:12544
    v_permlane16_swap_b32 v192, v193
    ds_write_b32 v1, v169 offset:12800
    ds_write_b32 v1, v173 offset:13056
    v_max_u32 v192, v192, v193
    ds_write_b32 v1, v177 offset:13312
    ds_write_b32 v1, v181 offset:13568
    v_mov_b32 v193, v192
    ds_write_b32 v1, v185 offset:13824
    ds_write_b32 v1, v189 offset:14080
    v_permlane32_swap_b32 v192, v193
    v_max_u32 v192, v192, v193
    v_max_u32 v192, 0x61, v192
    v_min_u32 v192, 0xdc, v192
    ds_write_b32 v255, v192 offset:24580
    s_nop 0
H_W0:
    s_mov_b32 s27, 0
LW_HW:
    ds_read_b32 v1, v255 offset:24580
    s_add_u32 s27, s27, 1
    s_waitcnt lgkmcnt(0)
    v_readfirstlane_b32 s33, v1
    s_cmp_gt_u32 s27, 0xc3500
    s_nop 3
    s_cbranch_scc1 LWX_HW
    s_cmp_ge_u32 s33, 1
    s_cbranch_scc1 LWX_HW
    s_sleep 1
    s_branch LW_HW
LWX_HW:
    s_add_u32 s16, s46, 0
    buffer_load_dwordx4 v[64:67], v245, s[8:11], s16 offen sc1
    s_add_u32 s16, s46, 4096
    buffer_load_dwordx4 v[68:71], v245, s[8:11], s16 offen sc1
    s_add_u32 s16, s46, 8192
    buffer_load_dwordx4 v[72:75], v245, s[8:11], s16 offen sc1
    s_add_u32 s16, s46, 12288
    buffer_load_dwordx4 v[76:79], v245, s[8:11], s16 offen sc1
    ds_read_b32 v80, v252 offset:12288
    ds_read_b32 v81, v252 offset:12544
    ds_read_b32 v82, v252 offset:12800
    ds_read_b32 v83, v252 offset:13056
    s_sub_u32 s24, 127, s33
    s_lshl_b32 s24, s24, 23
    s_waitcnt lgkmcnt(0)
    v_lshrrev_b32 v80, v253, v80
    v_lshrrev_b32 v81, v253, v81
    v_lshrrev_b32 v82, v253, v82
    v_lshrrev_b32 v83, v253, v83
    v_bfe_u32 v84, v80, 0, 8
    v_bfe_u32 v85, v80, 8, 8
    v_bfe_u32 v86, v81, 0, 8
    v_bfe_u32 v87, v81, 8, 8
    v_bfe_u32 v88, v82, 0, 8
    v_bfe_u32 v89, v82, 8, 8
    v_bfe_u32 v90, v83, 0, 8
    v_bfe_u32 v91, v83, 8, 8
    v_lshl_add_u32 v84, v84, 23, s24
    v_lshl_add_u32 v85, v85, 23, s24
    v_lshl_add_u32 v86, v86, 23, s24
    v_lshl_add_u32 v87, v87, 23, s24
    v_lshl_add_u32 v88, v88, 23, s24
    v_lshl_add_u32 v89, v89, 23, s24
    v_lshl_add_u32 v90, v90, 23, s24
    v_lshl_add_u32 v91, v91, 23, s24
    v_cvt_pk_f16_f32 v84, v84, v84
    v_cvt_pk_f16_f32 v85, v85, v85
    v_cvt_pk_f16_f32 v86, v86, v86
    v_cvt_pk_f16_f32 v87, v87, v87
    v_cvt_pk_f16_f32 v88, v88, v88
    v_cvt_pk_f16_f32 v89, v89, v89
    v_cvt_pk_f16_f32 v90, v90, v90
    v_cvt_pk_f16_f32 v91, v91, v91
    v_pk_mul_f16 v92, v16, v84
    v_pk_mul_f16 v93, v17, v85
    v_pk_mul_f16 v94, v18, v86
    v_pk_mul_f16 v95, v19, v87
    v_pk_mul_f16 v96, v20, v88
    v_pk_mul_f16 v97, v21, v89
    v_pk_mul_f16 v98, v22, v90
    v_pk_mul_f16 v99, v23, v91
    v_add_u32 v1, 80256, v251
    s_waitcnt vmcnt(3)
    s_nop 0
    v_pk_mul_f16 v100, v64, v84
    v_pk_mul_f16 v106, v65, v92 op_sel:[0,0] op_sel_hi:[1,0]
    v_pk_mul_f16 v101, v66, v85
    v_pk_mul_f16 v107, v67, v93 op_sel:[0,0] op_sel_hi:[1,0]
    v_pk_fma_f16 v102, v65, v92, v106 op_sel:[1,1,0] op_sel_hi:[0,1,1] neg_lo:[1,0,0]
    v_pk_fma_f16 v104, v65, v92, v106 op_sel:[1,1,0] op_sel_hi:[0,1,1] neg_hi:[1,0,0]
    v_pk_fma_f16 v103, v67, v93, v107 op_sel:[1,1,0] op_sel_hi:[0,1,1] neg_lo:[1,0,0]
    v_pk_fma_f16 v105, v67, v93, v107 op_sel:[1,1,0] op_sel_hi:[0,1,1] neg_hi:[1,0,0]
    ds_write_b64 v1, v[100:101] offset:0
    ds_write_b64 v1, v[102:103] offset:4096
    ds_write_b64 v1, v[104:105] offset:8192
    s_waitcnt vmcnt(2)
    s_nop 0
    v_pk_mul_f16 v108, v68, v86
    v_pk_mul_f16 v114, v69, v94 op_sel:[0,0] op_sel_hi:[1,0]
    v_pk_mul_f16 v109, v70, v87
    v_pk_mul_f16 v115, v71, v95 op_sel:[0,0] op_sel_hi:[1,0]
    v_pk_fma_f16 v110, v69, v94, v114 op_sel:[1,1,0] op_sel_hi:[0,1,1] neg_lo:[1,0,0]
    v_pk_fma_f16 v112, v69, v94, v114 op_sel:[1,1,0] op_sel_hi:[0,1,1] neg_hi:[1,0,0]
    v_pk_fma_f16 v111, v71, v95, v115 op_sel:[1,1,0] op_sel_hi:[0,1,1] neg_lo:[1,0,0]
    v_pk_fma_f16 v113, v71, v95, v115 op_sel:[1,1,0] op_sel_hi:[0,1,1] neg_hi:[1,0,0]
    ds_write_b64 v1, v[108:109] offset:1024
    ds_write_b64 v1, v[110:111] offset:5120
    ds_write_b64 v1, v[112:113] offset:9216
    s_waitcnt vmcnt(1)
    s_nop 0
    v_pk_mul_f16 v116, v72, v88
    v_pk_mul_f16 v122, v73, v96 op_sel:[0,0] op_sel_hi:[1,0]
    v_pk_mul_f16 v117, v74, v89
    v_pk_mul_f16 v123, v75, v97 op_sel:[0,0] op_sel_hi:[1,0]
    v_pk_fma_f16 v118, v73, v96, v122 op_sel:[1,1,0] op_sel_hi:[0,1,1] neg_lo:[1,0,0]
    v_pk_fma_f16 v120, v73, v96, v122 op_sel:[1,1,0] op_sel_hi:[0,1,1] neg_hi:[1,0,0]
    v_pk_fma_f16 v119, v75, v97, v123 op_sel:[1,1,0] op_sel_hi:[0,1,1] neg_lo:[1,0,0]
    v_pk_fma_f16 v121, v75, v97, v123 op_sel:[1,1,0] op_sel_hi:[0,1,1] neg_hi:[1,0,0]
    ds_write_b64 v1, v[116:117] offset:2048
    ds_write_b64 v1, v[118:119] offset:6144
    ds_write_b64 v1, v[120:121] offset:10240
    s_waitcnt vmcnt(0)
    s_nop 0
    v_pk_mul_f16 v124, v76, v90
    v_pk_mul_f16 v130, v77, v98 op_sel:[0,0] op_sel_hi:[1,0]
    v_pk_mul_f16 v125, v78, v91
    v_pk_mul_f16 v131, v79, v99 op_sel:[0,0] op_sel_hi:[1,0]
    v_pk_fma_f16 v126, v77, v98, v130 op_sel:[1,1,0] op_sel_hi:[0,1,1] neg_lo:[1,0,0]
    v_pk_fma_f16 v128, v77, v98, v130 op_sel:[1,1,0] op_sel_hi:[0,1,1] neg_hi:[1,0,0]
    v_pk_fma_f16 v127, v79, v99, v131 op_sel:[1,1,0] op_sel_hi:[0,1,1] neg_lo:[1,0,0]
    v_pk_fma_f16 v129, v79, v99, v131 op_sel:[1,1,0] op_sel_hi:[0,1,1] neg_hi:[1,0,0]
    ds_write_b64 v1, v[124:125] offset:3072
    ds_write_b64 v1, v[126:127] offset:7168
    ds_write_b64 v1, v[128:129] offset:11264
    s_mov_b64 exec, 1
    ds_add_u32 v255, v30 offset:24588
    s_mov_b64 exec, -1
    s_setprio 0
    s_add_u32 s17, s19, 0x404000
    s_mov_b32 s27, 0
LS_WS1:
    ds_read_b32 v4, v255 offset:24652
    ds_read_b64 v[140:141], v248 offset:24832
    ds_read_b64 v[142:143], v248 offset:26048
    ds_read_b64 v[144:145], v248 offset:29696
    ds_read_b64 v[146:147], v248 offset:30912
    ds_read_b64 v[148:149], v248 offset:34560
    ds_read_b64 v[150:151], v248 offset:35776
    ds_read_b64 v[152:153], v248 offset:39424
    ds_read_b64 v[154:155], v248 offset:40640
    s_add_u32 s27, s27, 1
    s_waitcnt lgkmcnt(8)
    v_readfirstlane_b32 s16, v4
    s_cmp_gt_u32 s27, 0xc3500
    s_nop 3
    s_cbranch_scc1 LSX_WS1
    s_cmp_ge_u32 s16, 4
    s_cbranch_scc0 LS_WS1
LSX_WS1:
    s_waitcnt lgkmcnt(6)
    s_add_u32 s16, s17, 0x0
    buffer_store_dwordx4 v[140:143], v249, s[8:11], s16 offen sc1
    s_waitcnt lgkmcnt(4)
    s_add_u32 s16, s17, 0x200000
    buffer_store_dwordx4 v[144:147], v249, s[8:11], s16 offen sc1
    s_waitcnt lgkmcnt(2)
    s_add_u32 s16, s17, 0x400000
    buffer_store_dwordx4 v[148:151], v249, s[8:11], s16 offen sc1
    s_waitcnt lgkmcnt(0)
    s_add_u32 s16, s17, 0x600000
    buffer_store_dwordx4 v[152:155], v249, s[8:11], s16 offen sc1
    s_lshl_b32 s16, s2, 12
    s_nop 0
    s_add_u32 s16, s16, 0x1100000
    buffer_store_dwordx4 v[236:239], v245, s[8:11], s16 offen sc1
    ds_read_b32 v80, v252 offset:13312
    ds_read_b32 v81, v252 offset:13568
    ds_read_b32 v82, v252 offset:13824
    ds_read_b32 v83, v252 offset:14080
    s_sub_u32 s24, 127, s33
    s_lshl_b32 s24, s24, 23
    s_waitcnt lgkmcnt(0)
    v_lshrrev_b32 v80, v253, v80
    v_lshrrev_b32 v81, v253, v81
    v_lshrrev_b32 v82, v253, v82
    v_lshrrev_b32 v83, v253, v83
    v_bfe_u32 v84, v80, 0, 8
    v_bfe_u32 v85, v80, 8, 8
    v_bfe_u32 v86, v81, 0, 8
    v_bfe_u32 v87, v81, 8, 8
    v_bfe_u32 v88, v82, 0, 8
    v_bfe_u32 v89, v82, 8, 8
    v_bfe_u32 v90, v83, 0, 8
    v_bfe_u32 v91, v83, 8, 8
    v_lshl_add_u32 v84, v84, 23, s24
    v_lshl_add_u32 v85, v85, 23, s24
    v_lshl_add_u32 v86, v86, 23, s24
    v_lshl_add_u32 v87, v87, 23, s24
    v_lshl_add_u32 v88, v88, 23, s24
    v_lshl_add_u32 v89, v89, 23, s24
    v_lshl_add_u32 v90, v90, 23, s24
    v_lshl_add_u32 v91, v91, 23, s24
    v_cvt_pk_f16_f32 v84, v84, v84
    v_cvt_pk_f16_f32 v85, v85, v85
    v_cvt_pk_f16_f32 v86, v86, v86
    v_cvt_pk_f16_f32 v87, v87, v87
    v_cvt_pk_f16_f32 v88, v88, v88
    v_cvt_pk_f16_f32 v89, v89, v89
    v_cvt_pk_f16_f32 v90, v90, v90
    v_cvt_pk_f16_f32 v91, v91, v91
    v_pk_mul_f16 v92, v16, v84
    v_pk_mul_f16 v93, v17, v85
    v_pk_mul_f16 v94, v18, v86
    v_pk_mul_f16 v95, v19, v87
    v_pk_mul_f16 v96, v20, v88
    v_pk_mul_f16 v97, v21, v89
    v_pk_mul_f16 v98, v22, v90
    v_pk_mul_f16 v99, v23, v91
    s_lshl_b32 s15, s33, 23
    s_waitcnt vmcnt(0)
    s_mov_b64 exec, 1
    ds_add_u32 v255, v30 offset:24600
    s_mov_b64 exec, -1
    s_cmp_eq_u32 s3, 4
    s_cbranch_scc1 H_RED
    s_mov_b32 s27, 0
LW_HH:
    ds_read_b32 v1, v255 offset:24592
    s_add_u32 s27, s27, 1
    s_waitcnt lgkmcnt(0)
    v_readfirstlane_b32 s16, v1
    s_cmp_gt_u32 s27, 0xc3500
    s_nop 3
    s_cbranch_scc1 LWX_HH
    s_cmp_ge_u32 s16, 1
    s_cbranch_scc1 LWX_HH
    s_sleep 2
    s_branch LW_HH
LWX_HH:
H_B0:
    s_add_u32 s16, s46, 16384
    buffer_load_dwordx4 v[64:67], v245, s[8:11], s16 offen sc1
    s_add_u32 s16, s46, 20480
    buffer_load_dwordx4 v[68:71], v245, s[8:11], s16 offen sc1
    s_add_u32 s16, s46, 24576
    buffer_load_dwordx4 v[72:75], v245, s[8:11], s16 offen sc1
    s_add_u32 s16, s46, 28672
    buffer_load_dwordx4 v[76:79], v245, s[8:11], s16 offen sc1
    v_add_u32 v1, 44288, v251
    s_waitcnt vmcnt(3)
    s_nop 0
    v_pk_mul_f16 v100, v64, v84
    v_pk_mul_f16 v106, v65, v92 op_sel:[0,0] op_sel_hi:[1,0]
    v_pk_mul_f16 v101, v66, v85
    v_pk_mul_f16 v107, v67, v93 op_sel:[0,0] op_sel_hi:[1,0]
    v_pk_fma_f16 v102, v65, v92, v106 op_sel:[1,1,0] op_sel_hi:[0,1,1] neg_lo:[1,0,0]
    v_pk_fma_f16 v104, v65, v92, v106 op_sel:[1,1,0] op_sel_hi:[0,1,1] neg_hi:[1,0,0]
    v_pk_fma_f16 v103, v67, v93, v107 op_sel:[1,1,0] op_sel_hi:[0,1,1] neg_lo:[1,0,0]
    v_pk_fma_f16 v105, v67, v93, v107 op_sel:[1,1,0] op_sel_hi:[0,1,1] neg_hi:[1,0,0]
    ds_write_b64 v1, v[100:101] offset:0
    ds_write_b64 v1, v[102:103] offset:4096
    ds_write_b64 v1, v[104:105] offset:8192
    s_waitcnt vmcnt(2)
    s_nop 0
    v_pk_mul_f16 v108, v68, v86
    v_pk_mul_f16 v114, v69, v94 op_sel:[0,0] op_sel_hi:[1,0]
    v_pk_mul_f16 v109, v70, v87
    v_pk_mul_f16 v115, v71, v95 op_sel:[0,0] op_sel_hi:[1,0]
    v_pk_fma_f16 v110, v69, v94, v114 op_sel:[1,1,0] op_sel_hi:[0,1,1] neg_lo:[1,0,0]
    v_pk_fma_f16 v112, v69, v94, v114 op_sel:[1,1,0] op_sel_hi:[0,1,1] neg_hi:[1,0,0]
    v_pk_fma_f16 v111, v71, v95, v115 op_sel:[1,1,0] op_sel_hi:[0,1,1] neg_lo:[1,0,0]
    v_pk_fma_f16 v113, v71, v95, v115 op_sel:[1,1,0] op_sel_hi:[0,1,1] neg_hi:[1,0,0]
    ds_write_b64 v1, v[108:109] offset:1024
    ds_write_b64 v1, v[110:111] offset:5120
    ds_write_b64 v1, v[112:113] offset:9216
    s_waitcnt vmcnt(1)
    s_nop 0
    v_pk_mul_f16 v116, v72, v88
    v_pk_mul_f16 v122, v73, v96 op_sel:[0,0] op_sel_hi:[1,0]
    v_pk_mul_f16 v117, v74, v89
    v_pk_mul_f16 v123, v75, v97 op_sel:[0,0] op_sel_hi:[1,0]
    v_pk_fma_f16 v118, v73, v96, v122 op_sel:[1,1,0] op_sel_hi:[0,1,1] neg_lo:[1,0,0]
    v_pk_fma_f16 v120, v73, v96, v122 op_sel:[1,1,0] op_sel_hi:[0,1,1] neg_hi:[1,0,0]
    v_pk_fma_f16 v119, v75, v97, v123 op_sel:[1,1,0] op_sel_hi:[0,1,1] neg_lo:[1,0,0]
    v_pk_fma_f16 v121, v75, v97, v123 op_sel:[1,1,0] op_sel_hi:[0,1,1] neg_hi:[1,0,0]
    ds_write_b64 v1, v[116:117] offset:2048
    ds_write_b64 v1, v[118:119] offset:6144
    ds_write_b64 v1, v[120:121] offset:10240
    s_waitcnt vmcnt(0)
    s_nop 0
    v_pk_mul_f16 v124, v76, v90
    v_pk_mul_f16 v130, v77, v98 op_sel:[0,0] op_sel_hi:[1,0]
    v_pk_mul_f16 v125, v78, v91
    v_pk_mul_f16 v131, v79, v99 op_sel:[0,0] op_sel_hi:[1,0]
    v_pk_fma_f16 v126, v77, v98, v130 op_sel:[1,1,0] op_sel_hi:[0,1,1] neg_lo:[1,0,0]
    v_pk_fma_f16 v128, v77, v98, v130 op_sel:[1,1,0] op_sel_hi:[0,1,1] neg_hi:[1,0,0]
    v_pk_fma_f16 v127, v79, v99, v131 op_sel:[1,1,0] op_sel_hi:[0,1,1] neg_lo:[1,0,0]
    v_pk_fma_f16 v129, v79, v99, v131 op_sel:[1,1,0] op_sel_hi:[0,1,1] neg_hi:[1,0,0]
    ds_write_b64 v1, v[124:125] offset:3072
    ds_write_b64 v1, v[126:127] offset:7168
    ds_write_b64 v1, v[128:129] offset:11264
    s_mov_b64 exec, 1
    ds_add_u32 v255, v30 offset:24588
    s_mov_b64 exec, -1
    s_cmp_eq_u32 s3, 4
    s_cbranch_scc1 H_RED1
    s_sub_u32 s16, s3, 5
    s_lshl_b32 s24, s16, 10
    s_lshl_b32 s17, s2, 14
    s_add_u32 s17, s17, 0xc00000
    s_lshl_b32 s18, s2, 12
    s_add_u32 s18, s18, 0x1200000
    s_mov_b32 s27, 0
LW_HL0:
    ds_read_b32 v1, v255 offset:24668
    s_add_u32 s27, s27, 1
    s_waitcnt lgkmcnt(0)
    v_readfirstlane_b32 s16, v1
    s_cmp_gt_u32 s27, 0xc3500
    s_nop 3
    s_cbranch_scc1 LWX_HL0
    s_cmp_ge_u32 s16, 4
    s_cbranch_scc1 LWX_HL0
    s_sleep 2
    s_branch LW_HL0
LWX_HL0:
    s_add_u32 s25, s17, s24
    s_nop 0
    buffer_store_dwordx4 v[236:239], v244, s[8:11], s25 offen sc1
    buffer_store_dwordx4 v[236:239], v244, s[8:11], s25 offen offset:3072 sc1
    s_add_u32 s25, s25, 6144
    s_add_u32 s16, s17, 7168
    s_min_u32 s25, s25, s16
    buffer_store_dwordx4 v[236:239], v244, s[8:11], s25 offen sc1
    s_add_u32 s25, s18, s24
    buffer_store_dwordx4 v[236:239], v244, s[8:11], s25 offen sc1
    buffer_store_dwordx4 v[236:239], v244, s[8:11], s18 offen offset:3072 sc1
    s_add_u32 s17, s17, 8192
    s_waitcnt vmcnt(0)
    s_mov_b64 exec, 1
    ds_add_u32 v255, v30 offset:24672
    s_mov_b64 exec, -1
    s_mov_b32 s27, 0
LW_HL1:
    ds_read_b32 v1, v255 offset:24668
    s_add_u32 s27, s27, 1
    s_waitcnt lgkmcnt(0)
    v_readfirstlane_b32 s16, v1
    s_cmp_gt_u32 s27, 0xc3500
    s_nop 3
    s_cbranch_scc1 LWX_HL1
    s_cmp_ge_u32 s16, 8
    s_cbranch_scc1 LWX_HL1
    s_sleep 2
    s_branch LW_HL1
LWX_HL1:
    s_add_u32 s25, s17, s24
    buffer_store_dwordx4 v[236:239], v244, s[8:11], s25 offen sc1
    buffer_store_dwordx4 v[236:239], v244, s[8:11], s25 offen offset:3072 sc1
    s_add_u32 s25, s25, 6144
    s_add_u32 s16, s17, 7168
    s_min_u32 s25, s25, s16
    buffer_store_dwordx4 v[236:239], v244, s[8:11], s25 offen sc1
    s_waitcnt vmcnt(0)
    s_mov_b64 exec, 1
    ds_add_u32 v255, v30 offset:24672
    s_mov_b64 exec, -1
    s_branch L_FINAL
H_RED:
    v_bfe_u32 v1, v241, 1, 2
    v_and_b32 v2, 1, v241
    v_lshlrev_b32 v2, 4, v2
    v_mov_b32 v3, 0x3f80
    v_lshlrev_b32 v3, v2, v3
    v_cmp_eq_u32 vcc, 0, v1
    s_nop 1
    v_cndmask_b32 v24, 0, v3, vcc
    v_cmp_eq_u32 vcc, 1, v1
    s_nop 1
    v_cndmask_b32 v25, 0, v3, vcc
    v_cmp_eq_u32 vcc, 2, v1
    s_nop 1
    v_cndmask_b32 v26, 0, v3, vcc
    v_cmp_eq_u32 vcc, 3, v1
    s_nop 1
    v_cndmask_b32 v27, 0, v3, vcc
    v_and_b32 v254, 7, v241
    v_lshlrev_b32 v254, 13, v254
    v_and_b32 v1, 16, v241
    v_add_u32 v254, v254, v1
    s_lshr_b32 s38, s2, 5
    s_lshl_b32 s38, s38, 3
    s_and_b32 s39, s2, 7
    s_add_u32 s38, s38, s39
    s_bfe_u32 s16, s2, 0x20003
    s_lshl_b32 s39, s38, 2
    s_add_u32 s39, s39, s16
    s_lshl_b32 s39, s39, 5
    s_add_u32 s39, s39, 0x1300000
    s_lshl_b32 s38, s38, 14
    s_lshl_b32 s16, s16, 4
    s_add_u32 s38, s38, s16
    s_add_u32 s38, s38, 0x1000000
    s_mov_b32 s36, 0x3a000000
    s_sub_u32 s16, 254, s33
    s_lshl_b32 s16, s16, 23
    v_mov_b32 v8, s16
    v_mul_f32 v8, v8, v8
    v_mul_f32 v8, 0x3727c5ac, v8
    s_mov_b32 s27, 0
    s_nop 0
LW_HPS0:
    ds_read_b32 v1, v255 offset:24596
    s_add_u32 s27, s27, 1
    s_waitcnt lgkmcnt(0)
    v_readfirstlane_b32 s16, v1
    s_cmp_gt_u32 s27, 0xc3500
    s_nop 3
    s_cbranch_scc1 LWX_HPS0
    s_cmp_ge_u32 s16, 4
    s_cbranch_scc1 LWX_HPS0
    s_sleep 1
    s_branch LW_HPS0
LWX_HPS0:
    s_mov_b32 s27, 0
    s_sleep 14
H_POLL1_0:
    s_add_u32 s16, s38, 0
    s_nop 0
    buffer_load_dwordx4 v[32:35], v31, s[8:11], s16 offen sc1
    s_add_u32 s16, s38, 4096
    buffer_load_dwordx4 v[36:39], v31, s[8:11], s16 offen sc1
    s_add_u32 s16, s38, 8192
    buffer_load_dwordx4 v[40:43], v31, s[8:11], s16 offen sc1
    s_add_u32 s16, s38, 12288
    buffer_load_dwordx4 v[44:47], v31, s[8:11], s16 offen sc1
    s_waitcnt vmcnt(0)
    s_nop 0
    v_bitop3_b32 v1, v32, v33, v34 bitop3:0x80
    v_bitop3_b32 v2, v35, v36, v37 bitop3:0x80
    v_bitop3_b32 v1, v1, v38, v39 bitop3:0x80
    v_bitop3_b32 v2, v2, v40, v41 bitop3:0x80
    v_bitop3_b32 v1, v1, v42, v43 bitop3:0x80
    v_bitop3_b32 v2, v2, v44, v45 bitop3:0x80
    v_bitop3_b32 v1, v1, v46, v47 bitop3:0x80
    v_and_b32 v1, v1, v2
    v_and_b32 v1, 0x80008000, v1
    v_cmp_ne_u32 vcc, 0x80008000, v1
    s_add_u32 s27, s27, 1
    s_cmp_gt_u32 s27, 20000
    s_nop 2
    s_cbranch_scc1 H_POLL1_0X
    s_cbranch_vccnz H_POLL1_0
H_POLL1_0X:
    s_nop 0
    v_mfma_f32_16x16x32_bf16 v[48:51], v[24:27], v[32:35], 0
    v_mfma_f32_16x16x32_bf16 v[48:51], v[24:27], v[36:39], v[48:51]
    v_mfma_f32_16x16x32_bf16 v[48:51], v[24:27], v[40:43], v[48:51]
    v_mfma_f32_16x16x32_bf16 v[48:51], v[24:27], v[44:47], v[48:51]
    v_mov_b32 v1, 1
    s_nop 6
    v_add_f32_dpp v48, v48, v48 quad_perm:[1,0,3,2] row_mask:0xf bank_mask:0xf
    v_add_f32_dpp v49, v49, v49 quad_perm:[1,0,3,2] row_mask:0xf bank_mask:0xf
    v_add_f32_dpp v50, v50, v50 quad_perm:[1,0,3,2] row_mask:0xf bank_mask:0xf
    v_add_f32_dpp v51, v51, v51 quad_perm:[1,0,3,2] row_mask:0xf bank_mask:0xf
    v_add_f32_dpp v48, v48, v48 quad_perm:[2,3,0,1] row_mask:0xf bank_mask:0xf
    v_add_f32_dpp v49, v49, v49 quad_perm:[2,3,0,1] row_mask:0xf bank_mask:0xf
    v_add_f32_dpp v50, v50, v50 quad_perm:[2,3,0,1] row_mask:0xf bank_mask:0xf
    v_add_f32_dpp v51, v51, v51 quad_perm:[2,3,0,1] row_mask:0xf bank_mask:0xf
    v_add_f32_dpp v48, v48, v48 row_half_mirror row_mask:0xf bank_mask:0xf
    v_add_f32_dpp v49, v49, v49 row_half_mirror row_mask:0xf bank_mask:0xf
    v_add_f32_dpp v50, v50, v50 row_half_mirror row_mask:0xf bank_mask:0xf
    v_add_f32_dpp v51, v51, v51 row_half_mirror row_mask:0xf bank_mask:0xf
    v_add_f32_dpp v48, v48, v48 row_mirror row_mask:0xf bank_mask:0xf
    v_add_f32_dpp v49, v49, v49 row_mirror row_mask:0xf bank_mask:0xf
    v_add_f32_dpp v50, v50, v50 row_mirror row_mask:0xf bank_mask:0xf
    v_add_f32_dpp v51, v51, v51 row_mirror row_mask:0xf bank_mask:0xf
    v_fma_f32 v48, |v48|, s36, v8
    v_fma_f32 v49, |v49|, s36, v8
    v_fma_f32 v50, |v50|, s36, v8
    v_fma_f32 v51, |v51|, s36, v8
    v_rsq_f32 v48, v48
    v_rsq_f32 v49, v49
    v_rsq_f32 v50, v50
    v_rsq_f32 v51, v51
    v_mul_f32 v48, 0.5, v48
    v_mul_f32 v49, 0.5, v49
    v_mul_f32 v50, 0.5, v50
    v_mul_f32 v51, 0.5, v51
    v_or_b32 v48, 0x80000000, v48
    v_or_b32 v49, 0x80000000, v49
    v_or_b32 v50, 0x80000000, v50
    v_or_b32 v51, 0x80000000, v51
    s_mov_b64 exec, 0x00ff00ff
    buffer_store_dwordx4 v[48:51], v254, s[8:11], s39 offen sc1
    s_mov_b64 exec, -1
    ds_write_b32 v255, v1 offset:24592
    s_add_u32 s39, s39, 0x10000
    s_branch H_B0
H_RED1:
    s_mov_b32 s27, 0
LW_HC1:
    ds_read_b32 v1, v255 offset:24672
    s_add_u32 s27, s27, 1
    s_waitcnt lgkmcnt(0)
    v_readfirstlane_b32 s16, v1
    s_cmp_gt_u32 s27, 0xc3500
    s_nop 3
    s_cbranch_scc1 LWX_HC1
    s_cmp_ge_u32 s16, 3
    s_cbranch_scc1 LWX_HC1
    s_sleep 2
    s_branch LW_HC1
LWX_HC1:
    s_mov_b32 s27, 0
LW_HPS1:
    ds_read_b32 v1, v255 offset:24596
    s_add_u32 s27, s27, 1
    s_waitcnt lgkmcnt(0)
    v_readfirstlane_b32 s16, v1
    s_cmp_gt_u32 s27, 0xc3500
    s_nop 3
    s_cbranch_scc1 LWX_HPS1
    s_cmp_ge_u32 s16, 8
    s_cbranch_scc1 LWX_HPS1
    s_sleep 1
    s_branch LW_HPS1
LWX_HPS1:
    s_mov_b32 s27, 0
    s_sleep 14
H_POLL1_1:
    s_add_u32 s16, s38, 1048576
    buffer_load_dwordx4 v[32:35], v31, s[8:11], s16 offen sc1
    s_add_u32 s16, s38, 1052672
    buffer_load_dwordx4 v[36:39], v31, s[8:11], s16 offen sc1
    s_add_u32 s16, s38, 1056768
    buffer_load_dwordx4 v[40:43], v31, s[8:11], s16 offen sc1
    s_add_u32 s16, s38, 1060864
    buffer_load_dwordx4 v[44:47], v31, s[8:11], s16 offen sc1
    s_waitcnt vmcnt(0)
    s_nop 0
    v_bitop3_b32 v1, v32, v33, v34 bitop3:0x80
    v_bitop3_b32 v2, v35, v36, v37 bitop3:0x80
    v_bitop3_b32 v1, v1, v38, v39 bitop3:0x80
    v_bitop3_b32 v2, v2, v40, v41 bitop3:0x80
    v_bitop3_b32 v1, v1, v42, v43 bitop3:0x80
    v_bitop3_b32 v2, v2, v44, v45 bitop3:0x80
    v_bitop3_b32 v1, v1, v46, v47 bitop3:0x80
    v_and_b32 v1, v1, v2
    v_and_b32 v1, 0x80008000, v1
    v_cmp_ne_u32 vcc, 0x80008000, v1
    s_add_u32 s27, s27, 1
    s_cmp_gt_u32 s27, 20000
    s_nop 2
    s_cbranch_scc1 H_POLL1_1X
    s_cbranch_vccnz H_POLL1_1
H_POLL1_1X:
    s_nop 0
    v_mfma_f32_16x16x32_bf16 v[48:51], v[24:27], v[32:35], 0
    v_mfma_f32_16x16x32_bf16 v[48:51], v[24:27], v[36:39], v[48:51]
    v_mfma_f32_16x16x32_bf16 v[48:51], v[24:27], v[40:43], v[48:51]
    v_mfma_f32_16x16x32_bf16 v[48:51], v[24:27], v[44:47], v[48:51]
    v_mov_b32 v1, 2
    s_nop 6
    v_add_f32_dpp v48, v48, v48 quad_perm:[1,0,3,2] row_mask:0xf bank_mask:0xf
    v_add_f32_dpp v49, v49, v49 quad_perm:[1,0,3,2] row_mask:0xf bank_mask:0xf
    v_add_f32_dpp v50, v50, v50 quad_perm:[1,0,3,2] row_mask:0xf bank_mask:0xf
    v_add_f32_dpp v51, v51, v51 quad_perm:[1,0,3,2] row_mask:0xf bank_mask:0xf
    v_add_f32_dpp v48, v48, v48 quad_perm:[2,3,0,1] row_mask:0xf bank_mask:0xf
    v_add_f32_dpp v49, v49, v49 quad_perm:[2,3,0,1] row_mask:0xf bank_mask:0xf
    v_add_f32_dpp v50, v50, v50 quad_perm:[2,3,0,1] row_mask:0xf bank_mask:0xf
    v_add_f32_dpp v51, v51, v51 quad_perm:[2,3,0,1] row_mask:0xf bank_mask:0xf
    v_add_f32_dpp v48, v48, v48 row_half_mirror row_mask:0xf bank_mask:0xf
    v_add_f32_dpp v49, v49, v49 row_half_mirror row_mask:0xf bank_mask:0xf
    v_add_f32_dpp v50, v50, v50 row_half_mirror row_mask:0xf bank_mask:0xf
    v_add_f32_dpp v51, v51, v51 row_half_mirror row_mask:0xf bank_mask:0xf
    v_add_f32_dpp v48, v48, v48 row_mirror row_mask:0xf bank_mask:0xf
    v_add_f32_dpp v49, v49, v49 row_mirror row_mask:0xf bank_mask:0xf
    v_add_f32_dpp v50, v50, v50 row_mirror row_mask:0xf bank_mask:0xf
    v_add_f32_dpp v51, v51, v51 row_mirror row_mask:0xf bank_mask:0xf
    v_fma_f32 v48, |v48|, s36, v8
    v_fma_f32 v49, |v49|, s36, v8
    v_fma_f32 v50, |v50|, s36, v8
    v_fma_f32 v51, |v51|, s36, v8
    v_rsq_f32 v48, v48
    v_rsq_f32 v49, v49
    v_rsq_f32 v50, v50
    v_rsq_f32 v51, v51
    v_mul_f32 v48, 0.5, v48
    v_mul_f32 v49, 0.5, v49
    v_mul_f32 v50, 0.5, v50
    v_mul_f32 v51, 0.5, v51
    v_or_b32 v48, 0x80000000, v48
    v_or_b32 v49, 0x80000000, v49
    v_or_b32 v50, 0x80000000, v50
    v_or_b32 v51, 0x80000000, v51
    s_mov_b64 exec, 0x00ff00ff
    buffer_store_dwordx4 v[48:51], v254, s[8:11], s39 offen sc1
    s_mov_b64 exec, -1
    ds_write_b32 v255, v1 offset:24592
    s_add_u32 s39, s39, 0x10000
    s_mov_b32 s27, 0
LW_HC2:
    ds_read_b32 v1, v255 offset:24672
    s_add_u32 s27, s27, 1
    s_waitcnt lgkmcnt(0)
    v_readfirstlane_b32 s16, v1
    s_cmp_gt_u32 s27, 0xc3500
    s_nop 3
    s_cbranch_scc1 LWX_HC2
    s_cmp_ge_u32 s16, 6
    s_cbranch_scc1 LWX_HC2
    s_sleep 2
    s_branch LW_HC2
LWX_HC2:
    s_mov_b32 s27, 0
LW_HPS2:
    ds_read_b32 v1, v255 offset:24596
    s_add_u32 s27, s27, 1
    s_waitcnt lgkmcnt(0)
    v_readfirstlane_b32 s16, v1
    s_cmp_gt_u32 s27, 0xc3500
    s_nop 3
    s_cbranch_scc1 LWX_HPS2
    s_cmp_ge_u32 s16, 12
    s_cbranch_scc1 LWX_HPS2
    s_sleep 1
    s_branch LW_HPS2
LWX_HPS2:
    s_mov_b32 s27, 0
    s_sleep 14
H_POLL1_2:
    s_nop 0
    s_add_u32 s16, s38, 2097152
    buffer_load_dwordx4 v[32:35], v31, s[8:11], s16 offen sc1
    s_add_u32 s16, s38, 2101248
    buffer_load_dwordx4 v[36:39], v31, s[8:11], s16 offen sc1
    s_add_u32 s16, s38, 2105344
    buffer_load_dwordx4 v[40:43], v31, s[8:11], s16 offen sc1
    s_add_u32 s16, s38, 2109440
    buffer_load_dwordx4 v[44:47], v31, s[8:11], s16 offen sc1
    s_waitcnt vmcnt(0)
    s_nop 0
    v_bitop3_b32 v1, v32, v33, v34 bitop3:0x80
    v_bitop3_b32 v2, v35, v36, v37 bitop3:0x80
    v_bitop3_b32 v1, v1, v38, v39 bitop3:0x80
    v_bitop3_b32 v2, v2, v40, v41 bitop3:0x80
    v_bitop3_b32 v1, v1, v42, v43 bitop3:0x80
    v_bitop3_b32 v2, v2, v44, v45 bitop3:0x80
    v_bitop3_b32 v1, v1, v46, v47 bitop3:0x80
    v_and_b32 v1, v1, v2
    v_and_b32 v1, 0x80008000, v1
    v_cmp_ne_u32 vcc, 0x80008000, v1
    s_add_u32 s27, s27, 1
    s_cmp_gt_u32 s27, 20000
    s_nop 2
    s_cbranch_scc1 H_POLL1_2X
    s_cbranch_vccnz H_POLL1_2
H_POLL1_2X:
    s_nop 0
    v_mfma_f32_16x16x32_bf16 v[48:51], v[24:27], v[32:35], 0
    v_mfma_f32_16x16x32_bf16 v[48:51], v[24:27], v[36:39], v[48:51]
    v_mfma_f32_16x16x32_bf16 v[48:51], v[24:27], v[40:43], v[48:51]
    v_mfma_f32_16x16x32_bf16 v[48:51], v[24:27], v[44:47], v[48:51]
    v_mov_b32 v1, 3
    s_nop 6
    v_add_f32_dpp v48, v48, v48 quad_perm:[1,0,3,2] row_mask:0xf bank_mask:0xf
    v_add_f32_dpp v49, v49, v49 quad_perm:[1,0,3,2] row_mask:0xf bank_mask:0xf
    v_add_f32_dpp v50, v50, v50 quad_perm:[1,0,3,2] row_mask:0xf bank_mask:0xf
    v_add_f32_dpp v51, v51, v51 quad_perm:[1,0,3,2] row_mask:0xf bank_mask:0xf
    v_add_f32_dpp v48, v48, v48 quad_perm:[2,3,0,1] row_mask:0xf bank_mask:0xf
    v_add_f32_dpp v49, v49, v49 quad_perm:[2,3,0,1] row_mask:0xf bank_mask:0xf
    v_add_f32_dpp v50, v50, v50 quad_perm:[2,3,0,1] row_mask:0xf bank_mask:0xf
    v_add_f32_dpp v51, v51, v51 quad_perm:[2,3,0,1] row_mask:0xf bank_mask:0xf
    v_add_f32_dpp v48, v48, v48 row_half_mirror row_mask:0xf bank_mask:0xf
    v_add_f32_dpp v49, v49, v49 row_half_mirror row_mask:0xf bank_mask:0xf
    v_add_f32_dpp v50, v50, v50 row_half_mirror row_mask:0xf bank_mask:0xf
    v_add_f32_dpp v51, v51, v51 row_half_mirror row_mask:0xf bank_mask:0xf
    v_add_f32_dpp v48, v48, v48 row_mirror row_mask:0xf bank_mask:0xf
    v_add_f32_dpp v49, v49, v49 row_mirror row_mask:0xf bank_mask:0xf
    v_add_f32_dpp v50, v50, v50 row_mirror row_mask:0xf bank_mask:0xf
    v_add_f32_dpp v51, v51, v51 row_mirror row_mask:0xf bank_mask:0xf
    v_fma_f32 v48, |v48|, s36, v8
    v_fma_f32 v49, |v49|, s36, v8
    v_fma_f32 v50, |v50|, s36, v8
    v_fma_f32 v51, |v51|, s36, v8
    v_rsq_f32 v48, v48
    v_rsq_f32 v49, v49
    v_rsq_f32 v50, v50
    v_rsq_f32 v51, v51
    v_mul_f32 v48, 0.5, v48
    v_mul_f32 v49, 0.5, v49
    v_mul_f32 v50, 0.5, v50
    v_mul_f32 v51, 0.5, v51
    v_or_b32 v48, 0x80000000, v48
    v_or_b32 v49, 0x80000000, v49
    v_or_b32 v50, 0x80000000, v50
    v_or_b32 v51, 0x80000000, v51
    s_mov_b64 exec, 0x00ff00ff
    buffer_store_dwordx4 v[48:51], v254, s[8:11], s39 offen sc1
    s_mov_b64 exec, -1
    ds_write_b32 v255, v1 offset:24592
    s_add_u32 s39, s39, 0x10000
L_FINAL:
    v_lshlrev_b32 v128, 6, v242
    v_lshl_add_u32 v128, v243, 5, v128
    buffer_load_dwordx4 v[8:11], v128, s[20:23], s26 offen offset:0
    buffer_load_dwordx4 v[12:15], v128, s[20:23], s26 offen offset:16
    v_bfe_u32 v129, v242, 2, 1
    v_lshlrev_b32 v129, 8, v129
    v_lshrrev_b32 v130, 3, v242
    v_lshl_add_u32 v129, v130, 6, v129
    v_and_b32_e64 v130, 3, v242
    v_lshl_add_u32 v129, v130, 4, v129
    v_lshl_add_u32 v129, v243, 9, v129
    ds_read_b128 v[16:19], v129 offset:0
    ds_read_b128 v[24:27], v129 offset:4096
    ds_read_b128 v[20:23], v129 offset:1024
    ds_read_b128 v[28:31], v129 offset:5120
    ds_read_b128 v[160:163], v129 offset:16384
    ds_read_b128 v[48:51], v244 offset:0
    ds_read_b128 v[164:167], v129 offset:17408
    ds_read_b128 v[52:55], v244 offset:1024
    ds_read_b128 v[168:171], v129 offset:18432
    ds_read_b128 v[56:59], v244 offset:2048
    ds_read_b128 v[172:175], v129 offset:19456
    ds_read_b128 v[60:63], v244 offset:3072
    s_mov_b32 s44, s40
    s_nop 0
    s_and_b32 s45, s41, 0xffff
    s_mov_b32 s46, 0x400000
    s_mov_b32 s47, 0x00020000
    v_lshrrev_b32 v130, 1, v240
    v_lshlrev_b32 v130, 6, v130
    v_and_b32 v131, 16, v244
    v_add_u32 v130, v130, v131
    s_lshr_b32 s24, s2, 1
    s_lshl_b32 s24, s24, 15
    s_and_b32 s17, s2, 1
    s_lshl_b32 s17, s17, 5
    s_add_u32 s24, s24, s17
    s_nop 0
    s_add_u32 s24, s24, 0xc00000
    s_add_u32 s17, s24, 16384
    s_mov_b32 s18, 0xa8002800
    v_cmp_eq_u32 vcc, 0, v243
    s_waitcnt lgkmcnt(0)
    v_pk_mul_f16 v131, v17, s18
    v_cndmask_b32 v160, v160, v131, vcc
    s_mov_b32 s27, 0
    s_nop 0
LW_FD:
    ds_read_b32 v131, v255 offset:24604
    s_add_u32 s27, s27, 1
    s_waitcnt lgkmcnt(0)
    v_readfirstlane_b32 s16, v131
    s_cmp_gt_u32 s27, 0xc3500
    s_nop 3
    s_cbranch_scc1 LWX_FD
    s_cmp_ge_u32 s16, 4
    s_cbranch_scc1 LWX_FD
    s_sleep 1
    s_branch LW_FD
LWX_FD:
    s_mov_b32 s27, 0
    s_sleep 12
F_POLL:
    buffer_load_dwordx4 v[0:3], v130, s[8:11], s24 offen sc1
    buffer_load_dwordx4 v[4:7], v130, s[8:11], s17 offen sc1
    s_waitcnt vmcnt(2)
    v_lshlrev_b32 v112, 16, v8
    v_and_b32 v113, 0xffff0000, v8
    v_lshlrev_b32 v114, 16, v9
    v_and_b32 v115, 0xffff0000, v9
    v_lshlrev_b32 v116, 16, v10
    v_and_b32 v117, 0xffff0000, v10
    v_lshlrev_b32 v118, 16, v11
    v_and_b32 v119, 0xffff0000, v11
    v_lshlrev_b32 v120, 16, v12
    v_and_b32 v121, 0xffff0000, v12
    v_lshlrev_b32 v122, 16, v13
    v_and_b32 v123, 0xffff0000, v13
    v_lshlrev_b32 v124, 16, v14
    v_and_b32 v125, 0xffff0000, v14
    v_lshlrev_b32 v126, 16, v15
    v_and_b32 v127, 0xffff0000, v15
    s_waitcnt vmcnt(0)
    v_bitop3_b32 v131, v0, v1, v2 bitop3:0x80
    v_bitop3_b32 v132, v3, v4, v5 bitop3:0x80
    v_bitop3_b32 v131, v131, v6, v7 bitop3:0x80
    v_and_b32 v131, v131, v132
    v_and_b32 v131, 1, v131
    v_cmp_eq_u32 vcc, 0, v131
    s_add_u32 s27, s27, 1
    s_cmp_gt_u32 s27, 20000
    s_nop 2
    s_cbranch_scc1 F_POLLX
    s_cbranch_vccnz F_POLL
F_POLLX:
    s_nop 0
    ds_write2st64_b32 v246, v0, v1 offset0:0 offset1:8
    ds_write2st64_b32 v246, v2, v3 offset0:16 offset1:24
    ds_write2st64_b32 v246, v4, v5 offset0:4 offset1:12
    ds_write2st64_b32 v246, v6, v7 offset0:20 offset1:28
    s_waitcnt lgkmcnt(0)
    s_barrier
    ds_read_b128 v[0:3], v250 offset:0
    ds_read_b128 v[4:7], v250 offset:1024
    s_waitcnt lgkmcnt(1)
    v_mfma_f32_32x32x16_f16 v[64:79], v[0:3], v[16:19], 0
    v_mfma_f32_32x32x16_f16 v[80:95], v[0:3], v[24:27], 0
    s_waitcnt lgkmcnt(0)
    v_mfma_f32_32x32x16_f16 v[64:79], v[4:7], v[20:23], v[64:79]
    v_mfma_f32_32x32x16_f16 v[80:95], v[4:7], v[28:31], v[80:95]
    s_nop 11
    s_nop 0
    v_cvt_pk_f16_f32 v80, v64, v80
    v_cvt_pk_f16_f32 v81, v65, v81
    v_cvt_pk_f16_f32 v82, v66, v82
    v_cvt_pk_f16_f32 v83, v67, v83
    v_pk_mul_f16 v96, v80, v160 op_sel:[0,0] op_sel_hi:[1,0]
    v_pk_mul_f16 v97, v81, v161 op_sel:[0,0] op_sel_hi:[1,0]
    v_pk_mul_f16 v98, v82, v162 op_sel:[0,0] op_sel_hi:[1,0]
    v_pk_mul_f16 v99, v83, v163 op_sel:[0,0] op_sel_hi:[1,0]
    v_pk_fma_f16 v96, v80, v160, v96 op_sel:[1,1,0] op_sel_hi:[0,1,1] neg_lo:[1,0,0]
    v_pk_fma_f16 v97, v81, v161, v97 op_sel:[1,1,0] op_sel_hi:[0,1,1] neg_lo:[1,0,0]
    v_pk_fma_f16 v98, v82, v162, v98 op_sel:[1,1,0] op_sel_hi:[0,1,1] neg_lo:[1,0,0]
    v_pk_fma_f16 v99, v83, v163, v99 op_sel:[1,1,0] op_sel_hi:[0,1,1] neg_lo:[1,0,0]
    v_cvt_pk_f16_f32 v84, v68, v84
    v_cvt_pk_f16_f32 v85, v69, v85
    v_mfma_f32_32x32x16_f16 v[144:159], v[96:99], v[48:51], 0
    v_cvt_pk_f16_f32 v86, v70, v86
    v_cvt_pk_f16_f32 v87, v71, v87
    v_pk_mul_f16 v100, v84, v164 op_sel:[0,0] op_sel_hi:[1,0]
    v_pk_mul_f16 v101, v85, v165 op_sel:[0,0] op_sel_hi:[1,0]
    v_pk_mul_f16 v102, v86, v166 op_sel:[0,0] op_sel_hi:[1,0]
    v_pk_mul_f16 v103, v87, v167 op_sel:[0,0] op_sel_hi:[1,0]
    v_pk_fma_f16 v100, v84, v164, v100 op_sel:[1,1,0] op_sel_hi:[0,1,1] neg_lo:[1,0,0]
    v_pk_fma_f16 v101, v85, v165, v101 op_sel:[1,1,0] op_sel_hi:[0,1,1] neg_lo:[1,0,0]
    v_pk_fma_f16 v102, v86, v166, v102 op_sel:[1,1,0] op_sel_hi:[0,1,1] neg_lo:[1,0,0]
    v_pk_fma_f16 v103, v87, v167, v103 op_sel:[1,1,0] op_sel_hi:[0,1,1] neg_lo:[1,0,0]
    v_cvt_pk_f16_f32 v88, v72, v88
    v_cvt_pk_f16_f32 v89, v73, v89
    v_mfma_f32_32x32x16_f16 v[144:159], v[100:103], v[52:55], v[144:159]
    v_cvt_pk_f16_f32 v90, v74, v90
    v_cvt_pk_f16_f32 v91, v75, v91
    v_pk_mul_f16 v104, v88, v168 op_sel:[0,0] op_sel_hi:[1,0]
    v_pk_mul_f16 v105, v89, v169 op_sel:[0,0] op_sel_hi:[1,0]
    v_pk_mul_f16 v106, v90, v170 op_sel:[0,0] op_sel_hi:[1,0]
    v_pk_mul_f16 v107, v91, v171 op_sel:[0,0] op_sel_hi:[1,0]
    v_pk_fma_f16 v104, v88, v168, v104 op_sel:[1,1,0] op_sel_hi:[0,1,1] neg_lo:[1,0,0]
    v_pk_fma_f16 v105, v89, v169, v105 op_sel:[1,1,0] op_sel_hi:[0,1,1] neg_lo:[1,0,0]
    v_pk_fma_f16 v106, v90, v170, v106 op_sel:[1,1,0] op_sel_hi:[0,1,1] neg_lo:[1,0,0]
    v_pk_fma_f16 v107, v91, v171, v107 op_sel:[1,1,0] op_sel_hi:[0,1,1] neg_lo:[1,0,0]
    v_cvt_pk_f16_f32 v92, v76, v92
    v_cvt_pk_f16_f32 v93, v77, v93
    v_mfma_f32_32x32x16_f16 v[144:159], v[104:107], v[56:59], v[144:159]
    v_cvt_pk_f16_f32 v94, v78, v94
    v_cvt_pk_f16_f32 v95, v79, v95
    v_pk_mul_f16 v108, v92, v172 op_sel:[0,0] op_sel_hi:[1,0]
    v_pk_mul_f16 v109, v93, v173 op_sel:[0,0] op_sel_hi:[1,0]
    v_pk_mul_f16 v110, v94, v174 op_sel:[0,0] op_sel_hi:[1,0]
    v_pk_mul_f16 v111, v95, v175 op_sel:[0,0] op_sel_hi:[1,0]
    v_pk_fma_f16 v108, v92, v172, v108 op_sel:[1,1,0] op_sel_hi:[0,1,1] neg_lo:[1,0,0]
    v_pk_fma_f16 v109, v93, v173, v109 op_sel:[1,1,0] op_sel_hi:[0,1,1] neg_lo:[1,0,0]
    v_pk_fma_f16 v110, v94, v174, v110 op_sel:[1,1,0] op_sel_hi:[0,1,1] neg_lo:[1,0,0]
    v_pk_fma_f16 v111, v95, v175, v111 op_sel:[1,1,0] op_sel_hi:[0,1,1] neg_lo:[1,0,0]
    s_nop 1
    v_mfma_f32_32x32x16_f16 v[144:159], v[108:111], v[60:63], v[144:159]
    s_nop 11
    v_fmac_f32 v112, s15, v144
    v_fmac_f32 v113, s15, v145
    v_fmac_f32 v114, s15, v146
    v_fmac_f32 v115, s15, v147
    v_fmac_f32 v116, s15, v148
    v_fmac_f32 v117, s15, v149
    v_fmac_f32 v118, s15, v150
    v_fmac_f32 v119, s15, v151
    v_fmac_f32 v120, s15, v152
    v_fmac_f32 v121, s15, v153
    v_fmac_f32 v122, s15, v154
    v_fmac_f32 v123, s15, v155
    v_fmac_f32 v124, s15, v156
    v_fmac_f32 v125, s15, v157
    v_fmac_f32 v126, s15, v158
    v_fmac_f32 v127, s15, v159
    v_cvt_pk_bf16_f32 v96, v112, v113
    v_cvt_pk_bf16_f32 v97, v114, v115
    v_cvt_pk_bf16_f32 v98, v116, v117
    v_cvt_pk_bf16_f32 v99, v118, v119
    v_cvt_pk_bf16_f32 v100, v120, v121
    v_cvt_pk_bf16_f32 v101, v122, v123
    v_cvt_pk_bf16_f32 v102, v124, v125
    v_cvt_pk_bf16_f32 v103, v126, v127
    buffer_store_dwordx4 v[96:99], v128, s[44:47], s26 offen offset:0
    buffer_store_dwordx4 v[100:103], v128, s[44:47], s26 offen offset:16
    s_or_b32 s16, s2, s3
    s_cmp_lg_u32 s16, 0
    s_cbranch_scc1 F_NOEP
    v_mov_b32 v131, s36
    s_mov_b32 s16, 0x1350000
    s_mov_b64 exec, 1
    buffer_store_dword v131, v255, s[8:11], s16 offen
    s_mov_b64 exec, -1
F_NOEP:
L_END:
    s_endpgm
.section .rodata,"a"
.p2align 6
.amdhsa_kernel interleave_layers__spectral_gfnet__spectral_gfnet__prompt_kernel
  .amdhsa_next_free_vgpr 256
  .amdhsa_next_free_sgpr 100
  .amdhsa_accum_offset 256
  .amdhsa_group_segment_fixed_size 0
  .amdhsa_kernarg_size 72
  .amdhsa_user_sgpr_count 2
  .amdhsa_user_sgpr_kernarg_segment_ptr 1
  .amdhsa_system_sgpr_workgroup_id_x 1
.end_amdhsa_kernel
```
